```python
import torch

def _softmax(x, axis=-1):
    return torch.softmax(x, dim=axis)
def _gelu(x):
    return torch.nn.functional.gelu(x, approximate="tanh")
def _silu(x):
    return torch.nn.functional.silu(x)
def _sigmoid(x):
    return torch.sigmoid(x)
def _layernorm(x, axis=-1, eps=1e-5):
    m = x.mean(dim=axis, keepdim=True)
    v = x.var(dim=axis, keepdim=True, unbiased=False)
    return (x - m) / torch.sqrt(v + eps)
def _scatter_add(tgt, idx, src, axis=0):
    return tgt.clone().index_add_(axis, idx, src)
def _segment_sum(src, seg, n):
    out = torch.zeros((n,) + src.shape[1:], dtype=src.dtype)
    return out.index_add_(0, seg, src)
def _pad(x, pw):
    flat = tuple(v for pair in reversed(pw) for v in pair)
    return torch.nn.functional.pad(x, flat)

kernel_name = 'sequential_preLN__mha_block_cached__glu_gated_swiglu__decode'

def setup_inputs():

    _w = (lambda a: (lambda t: t.to(torch.bfloat16) if t.is_floating_point() else t)(torch.as_tensor(a)))
    def _A_setup():
        B, Sq, D = 4, 1, 448
        H, Sk, Dh = 16, 4096, 256
        return {
            "x": _w((lambda *s: torch.randn(*s, dtype=torch.bfloat16) * 0.05)(B, Sq, D)),
            "k_cache": _w((lambda *s: torch.randn(*s, dtype=torch.bfloat16) * 1.6)(B, H, Sk, Dh)),
            "v_cache": _w((lambda *s: torch.randn(*s, dtype=torch.bfloat16) * 0.8)(B, H, Sk, Dh)),
            "wq": _w((lambda *s: torch.randn(*s, dtype=torch.bfloat16) * 1.6)(D, H * Dh) * (D ** -0.5)),
            "wo": _w((lambda *s: torch.randn(*s, dtype=torch.bfloat16) * 0.8)(H * Dh, D) * ((H * Dh) ** -0.5)),
        }
    _A_in = _A_setup()

    def _B_setup():
        B, S, D, F = 4, 1, 448, 1792
        return {
            "x": _w((lambda *s: torch.randn(*s, dtype=torch.bfloat16) * 0.05)(B, S, D)),
            "w1": _w((lambda *s: torch.randn(*s, dtype=torch.bfloat16) * 0.4)(D, F) * (2.0 / D) ** 0.5),
            "w3": _w((lambda *s: torch.randn(*s, dtype=torch.bfloat16) * 0.4)(D, F) * (2.0 / D) ** 0.5),
            "w2": _w((lambda *s: torch.randn(*s, dtype=torch.bfloat16) * 0.4)(F, D) * (2.0 / F) ** 0.5),
        }
    _B_in = _B_setup()

    return {
        "A_x": _A_in["x"],
        "A_k_cache": _A_in["k_cache"],
        "A_v_cache": _A_in["v_cache"],
        "A_wq": _A_in["wq"],
        "A_wo": _A_in["wo"],
        "B_x": _B_in["x"],
        "B_w1": _B_in["w1"],
        "B_w3": _B_in["w3"],
        "B_w2": _B_in["w2"],
    }

def reference(A_x, A_k_cache, A_v_cache, A_wq, A_wo, B_x, B_w1, B_w3, B_w2):
    def _A_ref(x, k_cache, v_cache, wq, wo):
        B, Sq, D = x.shape
        H, Dh = 16, 256
        q = (lambda x, *d: x.permute(*d))((x @ wq).reshape(B, Sq, H, Dh), 0, 2, 1, 3)
        scores = torch.einsum("bhqd,bhkd->bhqk", q, k_cache) * (Dh ** -0.5)
        p = _softmax(scores, axis=-1)
        o = torch.einsum("bhqk,bhkd->bhqd", p, v_cache)
        return (lambda x, *d: x.permute(*d))(o, 0, 2, 1, 3).reshape(B, Sq, H * Dh) @ wo

    def _B_ref(x, w1, w3, w2):
        gate = torch.einsum("bsd,df->bsf", x, w1)
        up = torch.einsum("bsd,df->bsf", x, w3)
        h = _silu(gate) * up
        out = torch.einsum("bsf,fd->bsd", h, w2)
        return out

    x = A_x
    h = x + _A_ref(_layernorm(x, axis=-1), A_k_cache, A_v_cache, A_wq, A_wo)
    h2 = h + _B_ref(_layernorm(h, axis=-1), B_w1, B_w3, B_w2)
    return h2
```

```asm
; @launch grid=(256,1,1) block=(512,1,1) lds=60992
.amdgcn_target "amdgcn-amd-amdhsa--gfx950"
.text
.globl sequential_preLN__mha_block_cached__glu_gated_swiglu__decode_kernel
.p2align 8
.type sequential_preLN__mha_block_cached__glu_gated_swiglu__decode_kernel,@function
sequential_preLN__mha_block_cached__glu_gated_swiglu__decode_kernel:
    s_cmp_ge_u32 s2, 256
    s_cbranch_scc1 L_end
    s_load_dwordx16 s[16:31], s[0:1], 0
    s_load_dwordx8 s[32:39], s[0:1], 64
    s_setprio 3
    v_lshrrev_b32 v10, 6, v0
    v_and_b32 v1, 63, v0
    v_readfirstlane_b32 s3, v10
    s_lshr_b32 s13, s2, 3
    s_and_b32 s9, s13, 3
    s_lshr_b32 s14, s13, 2
    s_and_b32 s8, s2, 7
    s_mul_i32 s8, s8, 7
    s_add_u32 s8, s8, s14
    s_cmp_lt_u32 s13, 28
    s_cselect_b32 s10, 1, 0
    s_and_b32 s4, s2, 7
    s_lshl_b32 s4, s4, 1
    s_and_b32 s6, s13, 1
    s_add_u32 s4, s4, s6
    s_bfe_u32 s5, s13, 0x20001
    s_bfe_u32 s7, s13, 0x10003
    s_lshr_b32 s6, s13, 4
    v_lshrrev_b32 v10, 3, v1
    v_and_b32 v11, 7, v1
    v_lshlrev_b32 v12, 4, v11
    v_lshl_add_u32 v2, v10, 9, v12
    v_lshl_add_u32 v13, v10, 13, v12
    v_mul_u32_u24 v7, 3584, v10
    v_add_u32 v7, v7, v12
    v_lshlrev_b32 v14, 4, v1
    v_mov_b32 v15, 0x40000000
    v_cmp_gt_u32 vcc, 56, v1
    s_nop 1
    v_cndmask_b32 v14, v15, v14, vcc
    s_lshl_b32 s11, s5, 4
    s_add_u32 s11, s11, s4
    s_lshl_b32 s11, s11, 21
    s_lshl_b32 s13, s7, 20
    s_add_u32 s11, s11, s13
    s_cmp_eq_u32 s6, 0
    s_cselect_b32 s13, 0, 524288
    s_lshl_b32 s14, s3, 12
    s_add_u32 s11, s11, s13
    s_add_u32 s11, s11, s14
    s_mov_b32 s12, s11
    s_mul_i32 s13, s5, 896
    s_mul_i32 s15, s3, 458752
    s_lshl_b32 s85, s4, 9
    s_add_u32 s15, s15, s85
    s_mov_b32 s84, s15
    s_waitcnt lgkmcnt(0)
    s_mov_b32 s40, s16
    s_mov_b32 s41, s17
    s_mov_b32 s42, 0xe00
    s_mov_b32 s43, 0x20000
    s_mov_b32 s52, s22
    s_mov_b32 s53, s23
    s_mov_b32 s54, 0x380000
    s_mov_b32 s55, 0x20000
    s_mov_b32 s44, s18
    s_mov_b32 s45, s19
    s_mov_b32 s46, 0x8000000
    s_mov_b32 s47, 0x20000
    s_mov_b32 s80, s38
    s_mov_b32 s81, s39
    s_mov_b32 s82, 0x20000000
    s_mov_b32 s83, 0x20000
    v_mov_b32 v50, v13
    buffer_load_dwordx4 v[52:55], v14, s[40:43], s13 offen
    buffer_load_dwordx4 v[208:211], v50, s[52:55], s84 offen offset:0 nt
    buffer_load_dwordx4 v[80:83], v2, s[44:47], s11 offen offset:0 nt
    buffer_load_dwordx4 v[212:215], v50, s[52:55], s84 offen offset:128 nt
    buffer_load_dwordx4 v[84:87], v2, s[44:47], s11 offen offset:128 nt
    buffer_load_dwordx4 v[216:219], v50, s[52:55], s84 offen offset:256 nt
    buffer_load_dwordx4 v[88:91], v2, s[44:47], s11 offen offset:256 nt
    buffer_load_dwordx4 v[220:223], v50, s[52:55], s84 offen offset:384 nt
    buffer_load_dwordx4 v[92:95], v2, s[44:47], s11 offen offset:384 nt
    s_add_u32 s11, s11, 32768
    s_add_u32 s84, s84, 65536
    s_mov_b32 s76, s36
    s_mov_b32 s77, s37
    s_mov_b32 s78, 0x100
    s_mov_b32 s79, 0x20000
    v_and_b32 v12, 1, v1
    v_lshlrev_b32 v12, 4, v12
    v_mov_b32 v13, 0xffff
    v_lshlrev_b32 v13, v12, v13
    v_lshrrev_b32 v12, 1, v11
    v_cmp_eq_u32 vcc, 0, v12
    s_nop 1
    v_cndmask_b32 v3, 0, v13, vcc
    v_cmp_eq_u32 vcc, 1, v12
    s_nop 1
    v_cndmask_b32 v4, 0, v13, vcc
    v_cmp_eq_u32 vcc, 2, v12
    s_nop 1
    v_cndmask_b32 v5, 0, v13, vcc
    v_cmp_eq_u32 vcc, 3, v12
    s_nop 1
    v_cndmask_b32 v6, 0, v13, vcc
    v_lshrrev_b32 v12, 5, v1
    v_lshlrev_b32 v12, 3, v12
    v_add_u32 v12, s3, v12
    v_mul_u32_u24 v8, 1824, v12
    v_lshl_add_u32 v8, v11, 5, v8
    v_and_b32 v12, 16, v1
    v_add_u32 v8, v8, v12
    s_lshl_b32 s13, s3, 11
    v_lshl_add_u32 v40, v1, 5, s13
    s_mul_i32 s13, s3, 2272
    v_lshl_add_u32 v41, v10, 2, s13
    s_mov_b32 s48, s20
    s_mov_b32 s49, s21
    s_mov_b32 s50, 0x8000000
    s_mov_b32 s51, 0x20000
    s_mov_b32 s56, s24
    s_mov_b32 s57, s25
    s_mov_b32 s58, 0x380000
    s_mov_b32 s59, 0x20000
    s_mov_b32 s60, s28
    s_mov_b32 s61, s29
    s_mov_b32 s62, 0x188000
    s_mov_b32 s63, 0x20000
    s_mov_b32 s64, s30
    s_mov_b32 s65, s31
    s_mov_b32 s66, 0x188000
    s_mov_b32 s67, 0x20000
    s_mov_b32 s68, s32
    s_mov_b32 s69, s33
    s_mov_b32 s70, 0x188000
    s_mov_b32 s71, 0x20000
    s_mov_b32 s72, s34
    s_mov_b32 s73, s35
    s_mov_b32 s74, 0xe00
    s_mov_b32 s75, 0x20000
    s_mul_i32 s13, s5, 114688
    s_lshl_b32 s14, s4, 2
    s_lshl_b32 s15, s7, 1
    s_add_u32 s15, s15, s6
    s_add_u32 s14, s14, s15
    s_lshl_b32 s14, s14, 5
    s_add_u32 s13, s13, 65536
    v_lshrrev_b32 v12, 3, v0
    v_lshlrev_b32 v12, 11, v12
    v_and_b32 v13, 4, v0
    v_lshl_add_u32 v12, v13, 2, v12
    v_add_u32 v12, s13, v12
    v_and_b32 v13, 3, v0
    v_mov_b32 v14, 0x40000000
    v_cmp_eq_u32 vcc, 0, v13
    s_nop 1
    v_cndmask_b32 v76, v14, v12, vcc
    s_cmp_eq_u32 s3, 7
    s_cselect_b32 s85, 0x40000000, 0
    v_or_b32 v76, s85, v76
    s_lshl_b32 s13, s5, 4
    s_add_u32 s13, s13, s4
    s_lshl_b32 s13, s13, 8
    s_lshl_b32 s15, s15, 3
    s_add_u32 s15, s15, s3
    s_lshl_b32 s15, s15, 3
    s_add_u32 s15, s15, s13
    v_mov_b32 v12, s15
    v_cmp_eq_u32 vcc, 0, v1
    s_nop 1
    v_cndmask_b32 v79, v14, v12, vcc
    s_cmp_lg_u32 s3, 0
    s_cbranch_scc1 L_nrsta
    v_mov_b32 v56, -1
    v_mov_b32 v57, -1
    v_mov_b32 v58, -1
    v_mov_b32 v59, -1
    v_lshlrev_b32 v12, 4, v1
    s_lshl_b32 s13, s2, 12
    buffer_store_dwordx4 v[56:59], v12, s[80:83], s13 offen offset:0 sc1
    buffer_store_dwordx4 v[56:59], v12, s[80:83], s13 offen offset:1024 sc1
    buffer_store_dwordx4 v[56:59], v12, s[80:83], s13 offen offset:2048 sc1
    buffer_store_dwordx4 v[56:59], v12, s[80:83], s13 offen offset:3072 sc1
L_nrsta:
    s_lshr_b32 s13, s2, 3
    s_mul_i32 s13, s13, 6
    s_lshr_b32 s13, s13, 5
    s_add_u32 s13, s13, 1
    s_cmp_eq_u32 s3, 0
    s_cselect_b32 s19, s13, 63
    v_mul_u32_u24 v9, 1824, v11
    v_lshrrev_b32 v12, 3, v0
    v_lshl_add_u32 v9, v12, 4, v9
    s_mul_i32 s15, s3, 200704
    s_lshl_b32 s85, s8, 6
    s_add_u32 s26, s15, s85
    s_mul_i32 s17, s8, 28672
    s_lshl_b32 s85, s3, 7
    s_add_u32 s17, s17, s85
    s_cmp_eq_u32 s10, 0
    s_cselect_b32 s26, 0x40000000, s26
    s_cselect_b32 s17, 0x40000000, s17
    s_mul_i32 s27, s3, 11264
    s_add_u32 s27, s27, 60992
    v_and_b32 v49, 0xffffffbf, v7
    v_mov_b32 v12, 0
    ds_write_b32 v12, v12 offset:60928
    ds_write_b32 v12, v12 offset:60968
    s_mov_b32 s16, 0x30d40
    v_mov_b32 v12, 0
    v_mov_b32 v13, 0
    v_mov_b32 v14, 0x3f803f80
    s_waitcnt vmcnt(8)
    v_dot2c_f32_bf16 v12, v52, v14
    v_dot2c_f32_bf16 v13, v52, v52
    v_dot2c_f32_bf16 v12, v53, v14
    v_dot2c_f32_bf16 v13, v53, v53
    v_dot2c_f32_bf16 v12, v54, v14
    v_dot2c_f32_bf16 v13, v54, v54
    v_dot2c_f32_bf16 v12, v55, v14
    v_dot2c_f32_bf16 v13, v55, v55
    v_lshlrev_b32 v60, 16, v52
    v_and_b32 v61, 0xffff0000, v52
    v_lshlrev_b32 v62, 16, v53
    v_and_b32 v63, 0xffff0000, v53
    v_lshlrev_b32 v64, 16, v54
    v_and_b32 v65, 0xffff0000, v54
    v_lshlrev_b32 v66, 16, v55
    v_and_b32 v67, 0xffff0000, v55
    v_add_f32_dpp v12, v12, v12 quad_perm:[1,0,3,2] row_mask:0xf bank_mask:0xf
    v_add_f32_dpp v13, v13, v13 quad_perm:[1,0,3,2] row_mask:0xf bank_mask:0xf
    s_nop 0
    v_add_f32_dpp v12, v12, v12 quad_perm:[2,3,0,1] row_mask:0xf bank_mask:0xf
    v_add_f32_dpp v13, v13, v13 quad_perm:[2,3,0,1] row_mask:0xf bank_mask:0xf
    s_nop 0
    v_add_f32_dpp v12, v12, v12 row_half_mirror row_mask:0xf bank_mask:0xf
    v_add_f32_dpp v13, v13, v13 row_half_mirror row_mask:0xf bank_mask:0xf
    s_nop 0
    v_add_f32_dpp v12, v12, v12 row_mirror row_mask:0xf bank_mask:0xf
    v_add_f32_dpp v13, v13, v13 row_mirror row_mask:0xf bank_mask:0xf
    v_mov_b32 v14, v12
    v_mov_b32 v15, v13
    s_nop 0
    v_permlane16_swap_b32 v12, v14
    v_permlane16_swap_b32 v13, v15
    v_add_f32 v12, v12, v14
    v_add_f32 v13, v13, v15
    v_mov_b32 v14, v12
    v_mov_b32 v15, v13
    s_nop 0
    v_permlane32_swap_b32 v12, v14
    v_permlane32_swap_b32 v13, v15
    v_add_f32 v12, v12, v14
    v_add_f32 v13, v13, v15
    v_mul_f32 v12, 0x3b124925, v12
    v_mul_f32 v13, 0x3b124925, v13
    v_fma_f32 v13, -v12, v12, v13
    v_max_f32 v13, 0, v13
    v_cvt_pk_bf16_f32 v12, v12, v13
    v_and_b32 v13, 0xffff0000, v12
    v_lshlrev_b32 v12, 16, v12
    v_add_f32 v13, 0x3727c5ac, v13
    v_cvt_pk_bf16_f32 v13, v13, v13
    v_and_b32 v13, 0xffff0000, v13
    v_sqrt_f32 v13, v13
    s_nop 0
    v_cvt_pk_bf16_f32 v13, v13, v13
    v_and_b32 v13, 0xffff0000, v13
    v_rcp_f32 v13, v13
    v_sub_f32 v60, v60, v12
    v_sub_f32 v61, v61, v12
    v_sub_f32 v62, v62, v12
    v_sub_f32 v63, v63, v12
    v_sub_f32 v64, v64, v12
    v_sub_f32 v65, v65, v12
    v_sub_f32 v66, v66, v12
    v_sub_f32 v67, v67, v12
    v_cvt_pk_bf16_f32 v60, v60, v60
    v_cvt_pk_bf16_f32 v61, v61, v61
    v_cvt_pk_bf16_f32 v62, v62, v62
    v_cvt_pk_bf16_f32 v63, v63, v63
    v_cvt_pk_bf16_f32 v64, v64, v64
    v_cvt_pk_bf16_f32 v65, v65, v65
    v_cvt_pk_bf16_f32 v66, v66, v66
    v_cvt_pk_bf16_f32 v67, v67, v67
    v_and_b32 v60, 0xffff0000, v60
    v_and_b32 v61, 0xffff0000, v61
    v_and_b32 v62, 0xffff0000, v62
    v_and_b32 v63, 0xffff0000, v63
    v_and_b32 v64, 0xffff0000, v64
    v_and_b32 v65, 0xffff0000, v65
    v_and_b32 v66, 0xffff0000, v66
    v_and_b32 v67, 0xffff0000, v67
    v_mul_f32 v60, v60, v13
    v_mul_f32 v61, v61, v13
    v_mul_f32 v62, v62, v13
    v_mul_f32 v63, v63, v13
    v_mul_f32 v64, v64, v13
    v_mul_f32 v65, v65, v13
    v_mul_f32 v66, v66, v13
    v_mul_f32 v67, v67, v13
    v_cvt_pk_bf16_f32 v60, v60, v60
    v_cvt_pk_bf16_f32 v61, v61, v61
    v_cvt_pk_bf16_f32 v62, v62, v62
    v_cvt_pk_bf16_f32 v63, v63, v63
    v_cvt_pk_bf16_f32 v64, v64, v64
    v_cvt_pk_bf16_f32 v65, v65, v65
    v_cvt_pk_bf16_f32 v66, v66, v66
    v_cvt_pk_bf16_f32 v67, v67, v67
    ds_write_b128 v40, v[60:63] offset:29184
    ds_write_b128 v40, v[64:67] offset:29200
    s_waitcnt lgkmcnt(0)
    ds_read_b32 v32, v41 offset:29184
    ds_read_b32 v33, v41 offset:29216
    ds_read_b32 v34, v41 offset:29248
    ds_read_b32 v35, v41 offset:29280
    ds_read_b32 v36, v41 offset:29312
    ds_read_b32 v37, v41 offset:29344
    ds_read_b32 v38, v41 offset:29376
    s_waitcnt lgkmcnt(6)
    v_and_b32 v52, v32, v3
    v_and_b32 v53, v32, v4
    v_and_b32 v54, v32, v5
    v_and_b32 v55, v32, v6
    s_waitcnt vmcnt(7)
    buffer_load_dwordx4 v[224:227], v50, s[52:55], s84 offen offset:0 nt
    s_waitcnt vmcnt(7)
    buffer_load_dwordx4 v[96:99], v2, s[44:47], s11 offen offset:0 nt
    s_waitcnt vmcnt(7)
    buffer_load_dwordx4 v[228:231], v50, s[52:55], s84 offen offset:128 nt
    s_waitcnt vmcnt(7)
    buffer_load_dwordx4 v[100:103], v2, s[44:47], s11 offen offset:128 nt
    s_waitcnt vmcnt(7)
    buffer_load_dwordx4 v[232:235], v50, s[52:55], s84 offen offset:256 nt
    s_waitcnt vmcnt(7)
    buffer_load_dwordx4 v[104:107], v2, s[44:47], s11 offen offset:256 nt
    s_waitcnt vmcnt(7)
    buffer_load_dwordx4 v[236:239], v50, s[52:55], s84 offen offset:384 nt
    s_waitcnt vmcnt(7)
    buffer_load_dwordx4 v[108:111], v2, s[44:47], s11 offen offset:384 nt
    s_add_u32 s11, s11, 32768
    s_add_u32 s84, s84, 65536
    s_waitcnt vmcnt(9)
    v_mfma_f32_16x16x32_bf16 v[60:63], v[52:55], v[208:211], 0
    v_mfma_f32_16x16x32_bf16 v[64:67], v[52:55], v[212:215], 0
    v_mfma_f32_16x16x32_bf16 v[68:71], v[52:55], v[216:219], 0
    v_mfma_f32_16x16x32_bf16 v[72:75], v[52:55], v[220:223], 0
    s_waitcnt lgkmcnt(5)
    v_and_b32 v56, v33, v3
    v_and_b32 v57, v33, v4
    v_and_b32 v58, v33, v5
    v_and_b32 v59, v33, v6
    s_waitcnt vmcnt(7)
    buffer_load_dwordx4 v[240:243], v50, s[52:55], s84 offen offset:0 nt
    s_waitcnt vmcnt(7)
    buffer_load_dwordx4 v[112:115], v2, s[44:47], s11 offen offset:0 nt
    s_waitcnt vmcnt(7)
    buffer_load_dwordx4 v[244:247], v50, s[52:55], s84 offen offset:128 nt
    s_waitcnt vmcnt(7)
    buffer_load_dwordx4 v[116:119], v2, s[44:47], s11 offen offset:128 nt
    s_waitcnt vmcnt(7)
    buffer_load_dwordx4 v[248:251], v50, s[52:55], s84 offen offset:256 nt
    s_waitcnt vmcnt(7)
    buffer_load_dwordx4 v[120:123], v2, s[44:47], s11 offen offset:256 nt
    s_waitcnt vmcnt(7)
    buffer_load_dwordx4 v[252:255], v50, s[52:55], s84 offen offset:384 nt
    s_waitcnt vmcnt(7)
    buffer_load_dwordx4 v[124:127], v2, s[44:47], s11 offen offset:384 nt
    s_add_u32 s11, s11, 32768
    s_add_u32 s84, s84, 65536
    s_waitcnt vmcnt(9)
    v_mfma_f32_16x16x32_bf16 v[60:63], v[56:59], v[224:227], v[60:63]
    v_mfma_f32_16x16x32_bf16 v[64:67], v[56:59], v[228:231], v[64:67]
    v_mfma_f32_16x16x32_bf16 v[68:71], v[56:59], v[232:235], v[68:71]
    v_mfma_f32_16x16x32_bf16 v[72:75], v[56:59], v[236:239], v[72:75]
    s_cmp_lg_u32 s19, 1
    s_cbranch_scc1 L_nb1a
    v_mov_b32 v12, 0
    v_mov_b32 v13, 1
    s_mov_b64 exec, 1
    buffer_atomic_add v13, v12, s[76:79], 0 offen sc1
    s_mov_b64 exec, -1
L_nb1a:
    s_waitcnt lgkmcnt(4)
    v_and_b32 v52, v34, v3
    v_and_b32 v53, v34, v4
    v_and_b32 v54, v34, v5
    v_and_b32 v55, v34, v6
    s_waitcnt vmcnt(7)
    buffer_load_dwordx4 v[208:211], v50, s[52:55], s84 offen offset:0 nt
    s_waitcnt vmcnt(7)
    buffer_load_dwordx4 v[128:131], v2, s[44:47], s11 offen offset:0 nt
    s_waitcnt vmcnt(7)
    buffer_load_dwordx4 v[212:215], v50, s[52:55], s84 offen offset:128 nt
    s_waitcnt vmcnt(7)
    buffer_load_dwordx4 v[132:135], v2, s[44:47], s11 offen offset:128 nt
    s_waitcnt vmcnt(7)
    buffer_load_dwordx4 v[216:219], v50, s[52:55], s84 offen offset:256 nt
    s_waitcnt vmcnt(7)
    buffer_load_dwordx4 v[136:139], v2, s[44:47], s11 offen offset:256 nt
    s_waitcnt vmcnt(7)
    buffer_load_dwordx4 v[220:223], v50, s[52:55], s84 offen offset:384 nt
    s_waitcnt vmcnt(7)
    buffer_load_dwordx4 v[140:143], v2, s[44:47], s11 offen offset:384 nt
    s_add_u32 s11, s11, 32768
    s_add_u32 s84, s84, 65536
    s_waitcnt vmcnt(9)
    v_mfma_f32_16x16x32_bf16 v[60:63], v[52:55], v[240:243], v[60:63]
    v_mfma_f32_16x16x32_bf16 v[64:67], v[52:55], v[244:247], v[64:67]
    v_mfma_f32_16x16x32_bf16 v[68:71], v[52:55], v[248:251], v[68:71]
    v_mfma_f32_16x16x32_bf16 v[72:75], v[52:55], v[252:255], v[72:75]
    s_cmp_lg_u32 s19, 2
    s_cbranch_scc1 L_nb2a
    v_mov_b32 v12, 0
    v_mov_b32 v13, 1
    s_mov_b64 exec, 1
    buffer_atomic_add v13, v12, s[76:79], 0 offen sc1
    s_mov_b64 exec, -1
L_nb2a:
    s_waitcnt lgkmcnt(3)
    v_and_b32 v56, v35, v3
    v_and_b32 v57, v35, v4
    v_and_b32 v58, v35, v5
    v_and_b32 v59, v35, v6
    s_waitcnt vmcnt(7)
    buffer_load_dwordx4 v[224:227], v50, s[52:55], s84 offen offset:0 nt
    s_waitcnt vmcnt(7)
    buffer_load_dwordx4 v[144:147], v2, s[44:47], s11 offen offset:0 nt
    s_waitcnt vmcnt(7)
    buffer_load_dwordx4 v[228:231], v50, s[52:55], s84 offen offset:128 nt
    s_waitcnt vmcnt(7)
    buffer_load_dwordx4 v[148:151], v2, s[44:47], s11 offen offset:128 nt
    s_waitcnt vmcnt(7)
    buffer_load_dwordx4 v[232:235], v50, s[52:55], s84 offen offset:256 nt
    s_waitcnt vmcnt(7)
    buffer_load_dwordx4 v[152:155], v2, s[44:47], s11 offen offset:256 nt
    s_waitcnt vmcnt(7)
    buffer_load_dwordx4 v[236:239], v50, s[52:55], s84 offen offset:384 nt
    s_waitcnt vmcnt(7)
    buffer_load_dwordx4 v[156:159], v2, s[44:47], s11 offen offset:384 nt
    s_add_u32 s11, s11, 32768
    s_add_u32 s84, s84, 65536
    s_waitcnt vmcnt(9)
    v_mfma_f32_16x16x32_bf16 v[60:63], v[56:59], v[208:211], v[60:63]
    v_mfma_f32_16x16x32_bf16 v[64:67], v[56:59], v[212:215], v[64:67]
    v_mfma_f32_16x16x32_bf16 v[68:71], v[56:59], v[216:219], v[68:71]
    v_mfma_f32_16x16x32_bf16 v[72:75], v[56:59], v[220:223], v[72:75]
    s_cmp_lg_u32 s19, 3
    s_cbranch_scc1 L_nb3a
    v_mov_b32 v12, 0
    v_mov_b32 v13, 1
    s_mov_b64 exec, 1
    buffer_atomic_add v13, v12, s[76:79], 0 offen sc1
    s_mov_b64 exec, -1
L_nb3a:
    s_waitcnt lgkmcnt(2)
    v_and_b32 v52, v36, v3
    v_and_b32 v53, v36, v4
    v_and_b32 v54, v36, v5
    v_and_b32 v55, v36, v6
    s_waitcnt vmcnt(7)
    buffer_load_dwordx4 v[240:243], v50, s[52:55], s84 offen offset:0 nt
    s_waitcnt vmcnt(7)
    buffer_load_dwordx4 v[160:163], v2, s[44:47], s11 offen offset:0 nt
    s_waitcnt vmcnt(7)
    buffer_load_dwordx4 v[244:247], v50, s[52:55], s84 offen offset:128 nt
    s_waitcnt vmcnt(7)
    buffer_load_dwordx4 v[164:167], v2, s[44:47], s11 offen offset:128 nt
    s_waitcnt vmcnt(7)
    buffer_load_dwordx4 v[248:251], v50, s[52:55], s84 offen offset:256 nt
    s_waitcnt vmcnt(7)
    buffer_load_dwordx4 v[168:171], v2, s[44:47], s11 offen offset:256 nt
    s_waitcnt vmcnt(7)
    buffer_load_dwordx4 v[252:255], v50, s[52:55], s84 offen offset:384 nt
    s_waitcnt vmcnt(7)
    buffer_load_dwordx4 v[172:175], v2, s[44:47], s11 offen offset:384 nt
    s_add_u32 s11, s11, 32768
    s_add_u32 s84, s84, 65536
    s_waitcnt vmcnt(9)
    v_mfma_f32_16x16x32_bf16 v[60:63], v[52:55], v[224:227], v[60:63]
    v_mfma_f32_16x16x32_bf16 v[64:67], v[52:55], v[228:231], v[64:67]
    v_mfma_f32_16x16x32_bf16 v[68:71], v[52:55], v[232:235], v[68:71]
    v_mfma_f32_16x16x32_bf16 v[72:75], v[52:55], v[236:239], v[72:75]
    s_cmp_lg_u32 s19, 4
    s_cbranch_scc1 L_nb4a
    v_mov_b32 v12, 0
    v_mov_b32 v13, 1
    s_mov_b64 exec, 1
    buffer_atomic_add v13, v12, s[76:79], 0 offen sc1
    s_mov_b64 exec, -1
L_nb4a:
    s_waitcnt lgkmcnt(1)
    v_and_b32 v56, v37, v3
    v_and_b32 v57, v37, v4
    v_and_b32 v58, v37, v5
    v_and_b32 v59, v37, v6
    s_waitcnt vmcnt(7)
    buffer_load_dwordx4 v[208:211], v50, s[52:55], s84 offen offset:0 nt
    s_waitcnt vmcnt(7)
    buffer_load_dwordx4 v[176:179], v2, s[44:47], s11 offen offset:0 nt
    s_waitcnt vmcnt(7)
    buffer_load_dwordx4 v[212:215], v50, s[52:55], s84 offen offset:128 nt
    s_waitcnt vmcnt(7)
    buffer_load_dwordx4 v[180:183], v2, s[44:47], s11 offen offset:128 nt
    s_waitcnt vmcnt(7)
    buffer_load_dwordx4 v[216:219], v50, s[52:55], s84 offen offset:256 nt
    s_waitcnt vmcnt(7)
    buffer_load_dwordx4 v[184:187], v2, s[44:47], s11 offen offset:256 nt
    s_waitcnt vmcnt(7)
    buffer_load_dwordx4 v[220:223], v50, s[52:55], s84 offen offset:384 nt
    s_waitcnt vmcnt(7)
    buffer_load_dwordx4 v[188:191], v2, s[44:47], s11 offen offset:384 nt
    s_add_u32 s11, s11, 32768
    s_add_u32 s84, s84, 65536
    s_waitcnt vmcnt(9)
    v_mfma_f32_16x16x32_bf16 v[60:63], v[56:59], v[240:243], v[60:63]
    v_mfma_f32_16x16x32_bf16 v[64:67], v[56:59], v[244:247], v[64:67]
    v_mfma_f32_16x16x32_bf16 v[68:71], v[56:59], v[248:251], v[68:71]
    v_mfma_f32_16x16x32_bf16 v[72:75], v[56:59], v[252:255], v[72:75]
    s_cmp_lg_u32 s19, 5
    s_cbranch_scc1 L_nb5a
    v_mov_b32 v12, 0
    v_mov_b32 v13, 1
    s_mov_b64 exec, 1
    buffer_atomic_add v13, v12, s[76:79], 0 offen sc1
    s_mov_b64 exec, -1
L_nb5a:
    s_waitcnt lgkmcnt(0)
    v_and_b32 v52, v38, v3
    v_and_b32 v53, v38, v4
    v_and_b32 v54, v38, v5
    v_and_b32 v55, v38, v6
    s_waitcnt vmcnt(7)
    buffer_load_dwordx4 v[192:195], v2, s[44:47], s11 offen offset:0 nt
    s_waitcnt vmcnt(7)
    buffer_load_dwordx4 v[196:199], v2, s[44:47], s11 offen offset:128 nt
    s_waitcnt vmcnt(7)
    buffer_load_dwordx4 v[200:203], v2, s[44:47], s11 offen offset:256 nt
    s_waitcnt vmcnt(7)
    buffer_load_dwordx4 v[204:207], v2, s[44:47], s11 offen offset:384 nt
    s_add_u32 s11, s11, 32768
    s_waitcnt vmcnt(5)
    v_mfma_f32_16x16x32_bf16 v[60:63], v[52:55], v[208:211], v[60:63]
    v_mfma_f32_16x16x32_bf16 v[64:67], v[52:55], v[212:215], v[64:67]
    v_mfma_f32_16x16x32_bf16 v[68:71], v[52:55], v[216:219], v[68:71]
    v_mfma_f32_16x16x32_bf16 v[72:75], v[52:55], v[220:223], v[72:75]
    s_cmp_lg_u32 s19, 6
    s_cbranch_scc1 L_nb6a
    v_mov_b32 v12, 0
    v_mov_b32 v13, 1
    s_mov_b64 exec, 1
    buffer_atomic_add v13, v12, s[76:79], 0 offen sc1
    s_mov_b64 exec, -1
L_nb6a:
    s_mov_b32 exec_lo, 0x00ff00ff
    s_mov_b32 exec_hi, 0xff00ff00
    ds_write_b128 v8, v[60:63] offset:0
    ds_write_b128 v8, v[64:67] offset:256
    ds_write_b128 v8, v[68:71] offset:512
    ds_write_b128 v8, v[72:75] offset:768
    s_mov_b64 exec, -1
    buffer_load_dwordx4 v[208:211], v2, s[44:47], s11 offen offset:0 nt
    buffer_load_dwordx4 v[212:215], v2, s[44:47], s11 offen offset:128 nt
    buffer_load_dwordx4 v[216:219], v2, s[44:47], s11 offen offset:256 nt
    buffer_load_dwordx4 v[220:223], v2, s[44:47], s11 offen offset:384 nt
    s_add_u32 s11, s11, 32768
    s_lshl_b32 s84, s4, 3
    s_add_u32 s84, s84, s3
    s_mul_i32 s84, s84, 28672
    v_lshlrev_b32 v15, 4, v11
    v_and_b32 v14, 0x1f8, v0
    s_waitcnt lgkmcnt(0)
    s_barrier
    ds_read_b128 v[60:63], v9 offset:0
    ds_read_b128 v[64:67], v9 offset:14592
    s_waitcnt lgkmcnt(0)
    v_add_f32 v60, v60, v64
    v_add_f32 v61, v61, v65
    v_add_f32 v62, v62, v66
    v_add_f32 v63, v63, v67
    v_add_f32_dpp v60, v60, v60 quad_perm:[1,0,3,2] row_mask:0xf bank_mask:0xf
    v_add_f32_dpp v61, v61, v61 quad_perm:[1,0,3,2] row_mask:0xf bank_mask:0xf
    v_add_f32_dpp v62, v62, v62 quad_perm:[1,0,3,2] row_mask:0xf bank_mask:0xf
    v_add_f32_dpp v63, v63, v63 quad_perm:[1,0,3,2] row_mask:0xf bank_mask:0xf
    v_add_f32_dpp v60, v60, v60 quad_perm:[2,3,0,1] row_mask:0xf bank_mask:0xf
    v_add_f32_dpp v61, v61, v61 quad_perm:[2,3,0,1] row_mask:0xf bank_mask:0xf
    v_add_f32_dpp v62, v62, v62 quad_perm:[2,3,0,1] row_mask:0xf bank_mask:0xf
    v_add_f32_dpp v63, v63, v63 quad_perm:[2,3,0,1] row_mask:0xf bank_mask:0xf
    v_add_f32_dpp v60, v60, v60 row_half_mirror row_mask:0xf bank_mask:0xf
    v_add_f32_dpp v61, v61, v61 row_half_mirror row_mask:0xf bank_mask:0xf
    v_add_f32_dpp v62, v62, v62 row_half_mirror row_mask:0xf bank_mask:0xf
    v_add_f32_dpp v63, v63, v63 row_half_mirror row_mask:0xf bank_mask:0xf
    v_cvt_pk_bf16_f32 v56, v60, v61
    v_cvt_pk_bf16_f32 v57, v62, v63
    ds_write_b64 v14, v[56:57] offset:58368
    s_waitcnt lgkmcnt(0)
    s_barrier
    ds_read_b128 v[16:19], v15 offset:58368
    ds_read_b128 v[20:23], v15 offset:58496
    ds_read_b128 v[24:27], v15 offset:58624
    ds_read_b128 v[28:31], v15 offset:58752
    s_waitcnt lgkmcnt(0)
    v_mov_b32 v32, 0
    v_mov_b32 v12, 0
    s_waitcnt vmcnt(56)
    v_dot2c_f32_bf16 v32, v80, v16
    v_dot2c_f32_bf16 v12, v81, v17
    v_dot2c_f32_bf16 v32, v82, v18
    v_dot2c_f32_bf16 v12, v83, v19
    v_dot2c_f32_bf16 v32, v84, v20
    v_dot2c_f32_bf16 v12, v85, v21
    v_dot2c_f32_bf16 v32, v86, v22
    v_dot2c_f32_bf16 v12, v87, v23
    v_dot2c_f32_bf16 v32, v88, v24
    v_dot2c_f32_bf16 v12, v89, v25
    v_dot2c_f32_bf16 v32, v90, v26
    v_dot2c_f32_bf16 v12, v91, v27
    v_dot2c_f32_bf16 v32, v92, v28
    v_dot2c_f32_bf16 v12, v93, v29
    v_dot2c_f32_bf16 v32, v94, v30
    v_dot2c_f32_bf16 v12, v95, v31
    s_nop 2
    v_add_f32 v32, v32, v12
    s_nop 1
    v_add_f32_dpp v32, v32, v32 quad_perm:[1,0,3,2] row_mask:0xf bank_mask:0xf
    s_nop 1
    v_add_f32_dpp v32, v32, v32 quad_perm:[2,3,0,1] row_mask:0xf bank_mask:0xf
    s_nop 1
    v_add_f32_dpp v32, v32, v32 row_half_mirror row_mask:0xf bank_mask:0xf
    v_cvt_pk_bf16_f32 v32, v32, v32
    v_and_b32 v32, 0xffff0000, v32
    v_mov_b32 v33, 0
    v_mov_b32 v12, 0
    s_waitcnt vmcnt(48)
    v_dot2c_f32_bf16 v33, v96, v16
    v_dot2c_f32_bf16 v12, v97, v17
    v_dot2c_f32_bf16 v33, v98, v18
    v_dot2c_f32_bf16 v12, v99, v19
    v_dot2c_f32_bf16 v33, v100, v20
    v_dot2c_f32_bf16 v12, v101, v21
    v_dot2c_f32_bf16 v33, v102, v22
    v_dot2c_f32_bf16 v12, v103, v23
    v_dot2c_f32_bf16 v33, v104, v24
    v_dot2c_f32_bf16 v12, v105, v25
    v_dot2c_f32_bf16 v33, v106, v26
    v_dot2c_f32_bf16 v12, v107, v27
    v_dot2c_f32_bf16 v33, v108, v28
    v_dot2c_f32_bf16 v12, v109, v29
    v_dot2c_f32_bf16 v33, v110, v30
    v_dot2c_f32_bf16 v12, v111, v31
    s_nop 2
    v_add_f32 v33, v33, v12
    s_nop 1
    v_add_f32_dpp v33, v33, v33 quad_perm:[1,0,3,2] row_mask:0xf bank_mask:0xf
    s_nop 1
    v_add_f32_dpp v33, v33, v33 quad_perm:[2,3,0,1] row_mask:0xf bank_mask:0xf
    s_nop 1
    v_add_f32_dpp v33, v33, v33 row_half_mirror row_mask:0xf bank_mask:0xf
    v_cvt_pk_bf16_f32 v33, v33, v33
    v_and_b32 v33, 0xffff0000, v33
    v_mov_b32 v34, 0
    v_mov_b32 v12, 0
    s_waitcnt vmcnt(40)
    v_dot2c_f32_bf16 v34, v112, v16
    v_dot2c_f32_bf16 v12, v113, v17
    v_dot2c_f32_bf16 v34, v114, v18
    v_dot2c_f32_bf16 v12, v115, v19
    v_dot2c_f32_bf16 v34, v116, v20
    v_dot2c_f32_bf16 v12, v117, v21
    v_dot2c_f32_bf16 v34, v118, v22
    v_dot2c_f32_bf16 v12, v119, v23
    v_dot2c_f32_bf16 v34, v120, v24
    v_dot2c_f32_bf16 v12, v121, v25
    v_dot2c_f32_bf16 v34, v122, v26
    v_dot2c_f32_bf16 v12, v123, v27
    v_dot2c_f32_bf16 v34, v124, v28
    v_dot2c_f32_bf16 v12, v125, v29
    v_dot2c_f32_bf16 v34, v126, v30
    v_dot2c_f32_bf16 v12, v127, v31
    s_waitcnt vmcnt(8)
    buffer_load_dwordx4 v[80:83], v2, s[44:47], s11 offen offset:0 nt
    buffer_load_dwordx4 v[84:87], v2, s[44:47], s11 offen offset:128 nt
    buffer_load_dwordx4 v[88:91], v2, s[44:47], s11 offen offset:256 nt
    buffer_load_dwordx4 v[92:95], v2, s[44:47], s11 offen offset:384 nt
    s_add_u32 s11, s11, 32768
    v_add_f32 v34, v34, v12
    s_nop 1
    v_add_f32_dpp v34, v34, v34 quad_perm:[1,0,3,2] row_mask:0xf bank_mask:0xf
    s_nop 1
    v_add_f32_dpp v34, v34, v34 quad_perm:[2,3,0,1] row_mask:0xf bank_mask:0xf
    s_nop 1
    v_add_f32_dpp v34, v34, v34 row_half_mirror row_mask:0xf bank_mask:0xf
    v_cvt_pk_bf16_f32 v34, v34, v34
    v_and_b32 v34, 0xffff0000, v34
    v_mov_b32 v35, 0
    v_mov_b32 v12, 0
    s_waitcnt vmcnt(36)
    v_dot2c_f32_bf16 v35, v128, v16
    v_dot2c_f32_bf16 v12, v129, v17
    v_dot2c_f32_bf16 v35, v130, v18
    v_dot2c_f32_bf16 v12, v131, v19
    v_dot2c_f32_bf16 v35, v132, v20
    v_dot2c_f32_bf16 v12, v133, v21
    v_dot2c_f32_bf16 v35, v134, v22
    v_dot2c_f32_bf16 v12, v135, v23
    v_dot2c_f32_bf16 v35, v136, v24
    v_dot2c_f32_bf16 v12, v137, v25
    v_dot2c_f32_bf16 v35, v138, v26
    v_dot2c_f32_bf16 v12, v139, v27
    v_dot2c_f32_bf16 v35, v140, v28
    v_dot2c_f32_bf16 v12, v141, v29
    v_dot2c_f32_bf16 v35, v142, v30
    v_dot2c_f32_bf16 v12, v143, v31
    s_nop 2
    v_add_f32 v35, v35, v12
    s_nop 1
    v_add_f32_dpp v35, v35, v35 quad_perm:[1,0,3,2] row_mask:0xf bank_mask:0xf
    s_nop 1
    v_add_f32_dpp v35, v35, v35 quad_perm:[2,3,0,1] row_mask:0xf bank_mask:0xf
    s_nop 1
    v_add_f32_dpp v35, v35, v35 row_half_mirror row_mask:0xf bank_mask:0xf
    v_cvt_pk_bf16_f32 v35, v35, v35
    v_and_b32 v35, 0xffff0000, v35
    v_mov_b32 v36, 0
    v_mov_b32 v12, 0
    s_waitcnt vmcnt(28)
    v_dot2c_f32_bf16 v36, v144, v16
    v_dot2c_f32_bf16 v12, v145, v17
    v_dot2c_f32_bf16 v36, v146, v18
    v_dot2c_f32_bf16 v12, v147, v19
    v_dot2c_f32_bf16 v36, v148, v20
    v_dot2c_f32_bf16 v12, v149, v21
    v_dot2c_f32_bf16 v36, v150, v22
    v_dot2c_f32_bf16 v12, v151, v23
    v_dot2c_f32_bf16 v36, v152, v24
    v_dot2c_f32_bf16 v12, v153, v25
    v_dot2c_f32_bf16 v36, v154, v26
    v_dot2c_f32_bf16 v12, v155, v27
    v_dot2c_f32_bf16 v36, v156, v28
    v_dot2c_f32_bf16 v12, v157, v29
    v_dot2c_f32_bf16 v36, v158, v30
    v_dot2c_f32_bf16 v12, v159, v31
    s_nop 2
    v_add_f32 v36, v36, v12
    s_cmp_lg_u32 s3, 0
    s_cbranch_scc1 L_c1a
    v_mov_b32 v50, 0
    buffer_load_dword v51, v50, s[76:79], 0 offen sc1
L_c1a:
    v_add_f32_dpp v36, v36, v36 quad_perm:[1,0,3,2] row_mask:0xf bank_mask:0xf
    s_nop 1
    v_add_f32_dpp v36, v36, v36 quad_perm:[2,3,0,1] row_mask:0xf bank_mask:0xf
    s_nop 1
    v_add_f32_dpp v36, v36, v36 row_half_mirror row_mask:0xf bank_mask:0xf
    v_cvt_pk_bf16_f32 v36, v36, v36
    v_and_b32 v36, 0xffff0000, v36
    v_mov_b32 v37, 0
    v_mov_b32 v12, 0
    s_waitcnt vmcnt(20)
    v_dot2c_f32_bf16 v37, v160, v16
    v_dot2c_f32_bf16 v12, v161, v17
    v_dot2c_f32_bf16 v37, v162, v18
    v_dot2c_f32_bf16 v12, v163, v19
    v_dot2c_f32_bf16 v37, v164, v20
    v_dot2c_f32_bf16 v12, v165, v21
    v_dot2c_f32_bf16 v37, v166, v22
    v_dot2c_f32_bf16 v12, v167, v23
    v_dot2c_f32_bf16 v37, v168, v24
    v_dot2c_f32_bf16 v12, v169, v25
    v_dot2c_f32_bf16 v37, v170, v26
    v_dot2c_f32_bf16 v12, v171, v27
    v_dot2c_f32_bf16 v37, v172, v28
    v_dot2c_f32_bf16 v12, v173, v29
    v_dot2c_f32_bf16 v37, v174, v30
    v_dot2c_f32_bf16 v12, v175, v31
    s_waitcnt vmcnt(8)
    buffer_load_dwordx4 v[96:99], v2, s[44:47], s11 offen offset:0 nt
    buffer_load_dwordx4 v[100:103], v2, s[44:47], s11 offen offset:128 nt
    buffer_load_dwordx4 v[104:107], v2, s[44:47], s11 offen offset:256 nt
    buffer_load_dwordx4 v[108:111], v2, s[44:47], s11 offen offset:384 nt
    s_add_u32 s11, s11, 32768
    v_add_f32 v37, v37, v12
    s_nop 1
    v_add_f32_dpp v37, v37, v37 quad_perm:[1,0,3,2] row_mask:0xf bank_mask:0xf
    s_nop 1
    v_add_f32_dpp v37, v37, v37 quad_perm:[2,3,0,1] row_mask:0xf bank_mask:0xf
    s_nop 1
    v_add_f32_dpp v37, v37, v37 row_half_mirror row_mask:0xf bank_mask:0xf
    v_cvt_pk_bf16_f32 v37, v37, v37
    v_and_b32 v37, 0xffff0000, v37
    v_mov_b32 v38, 0
    v_mov_b32 v12, 0
    s_waitcnt vmcnt(16)
    v_dot2c_f32_bf16 v38, v176, v16
    v_dot2c_f32_bf16 v12, v177, v17
    v_dot2c_f32_bf16 v38, v178, v18
    v_dot2c_f32_bf16 v12, v179, v19
    v_dot2c_f32_bf16 v38, v180, v20
    v_dot2c_f32_bf16 v12, v181, v21
    v_dot2c_f32_bf16 v38, v182, v22
    v_dot2c_f32_bf16 v12, v183, v23
    v_dot2c_f32_bf16 v38, v184, v24
    v_dot2c_f32_bf16 v12, v185, v25
    v_dot2c_f32_bf16 v38, v186, v26
    v_dot2c_f32_bf16 v12, v187, v27
    v_dot2c_f32_bf16 v38, v188, v28
    v_dot2c_f32_bf16 v12, v189, v29
    v_dot2c_f32_bf16 v38, v190, v30
    v_dot2c_f32_bf16 v12, v191, v31
    s_nop 2
    v_add_f32 v38, v38, v12
    s_nop 1
    v_add_f32_dpp v38, v38, v38 quad_perm:[1,0,3,2] row_mask:0xf bank_mask:0xf
    s_nop 1
    v_add_f32_dpp v38, v38, v38 quad_perm:[2,3,0,1] row_mask:0xf bank_mask:0xf
    s_nop 1
    v_add_f32_dpp v38, v38, v38 row_half_mirror row_mask:0xf bank_mask:0xf
    v_cvt_pk_bf16_f32 v38, v38, v38
    v_and_b32 v38, 0xffff0000, v38
    v_mov_b32 v39, 0
    v_mov_b32 v12, 0
    s_waitcnt vmcnt(12)
    v_dot2c_f32_bf16 v39, v192, v16
    v_dot2c_f32_bf16 v12, v193, v17
    v_dot2c_f32_bf16 v39, v194, v18
    v_dot2c_f32_bf16 v12, v195, v19
    v_dot2c_f32_bf16 v39, v196, v20
    v_dot2c_f32_bf16 v12, v197, v21
    v_dot2c_f32_bf16 v39, v198, v22
    v_dot2c_f32_bf16 v12, v199, v23
    v_dot2c_f32_bf16 v39, v200, v24
    v_dot2c_f32_bf16 v12, v201, v25
    v_dot2c_f32_bf16 v39, v202, v26
    v_dot2c_f32_bf16 v12, v203, v27
    v_dot2c_f32_bf16 v39, v204, v28
    v_dot2c_f32_bf16 v12, v205, v29
    v_dot2c_f32_bf16 v39, v206, v30
    v_dot2c_f32_bf16 v12, v207, v31
    s_nop 2
    v_add_f32 v39, v39, v12
    s_nop 1
    v_add_f32_dpp v39, v39, v39 quad_perm:[1,0,3,2] row_mask:0xf bank_mask:0xf
    s_nop 1
    v_add_f32_dpp v39, v39, v39 quad_perm:[2,3,0,1] row_mask:0xf bank_mask:0xf
    s_nop 1
    v_add_f32_dpp v39, v39, v39 row_half_mirror row_mask:0xf bank_mask:0xf
    v_cvt_pk_bf16_f32 v39, v39, v39
    v_and_b32 v39, 0xffff0000, v39
    s_setprio 2
    v_mov_b32 v40, 0
    v_mov_b32 v12, 0
    s_waitcnt vmcnt(8)
    v_dot2c_f32_bf16 v40, v208, v16
    v_dot2c_f32_bf16 v12, v209, v17
    v_dot2c_f32_bf16 v40, v210, v18
    v_dot2c_f32_bf16 v12, v211, v19
    v_dot2c_f32_bf16 v40, v212, v20
    v_dot2c_f32_bf16 v12, v213, v21
    v_dot2c_f32_bf16 v40, v214, v22
    v_dot2c_f32_bf16 v12, v215, v23
    v_dot2c_f32_bf16 v40, v216, v24
    v_dot2c_f32_bf16 v12, v217, v25
    v_dot2c_f32_bf16 v40, v218, v26
    v_dot2c_f32_bf16 v12, v219, v27
    v_dot2c_f32_bf16 v40, v220, v28
    v_dot2c_f32_bf16 v12, v221, v29
    v_dot2c_f32_bf16 v40, v222, v30
    v_dot2c_f32_bf16 v12, v223, v31
    buffer_load_dwordx4 v[112:115], v2, s[44:47], s11 offen offset:0 nt
    buffer_load_dwordx4 v[116:119], v2, s[44:47], s11 offen offset:128 nt
    buffer_load_dwordx4 v[120:123], v2, s[44:47], s11 offen offset:256 nt
    buffer_load_dwordx4 v[124:127], v2, s[44:47], s11 offen offset:384 nt
    s_add_u32 s11, s11, 32768
    v_add_f32 v40, v40, v12
    s_nop 1
    v_add_f32_dpp v40, v40, v40 quad_perm:[1,0,3,2] row_mask:0xf bank_mask:0xf
    s_nop 1
    v_add_f32_dpp v40, v40, v40 quad_perm:[2,3,0,1] row_mask:0xf bank_mask:0xf
    s_nop 1
    v_add_f32_dpp v40, v40, v40 row_half_mirror row_mask:0xf bank_mask:0xf
    v_cvt_pk_bf16_f32 v40, v40, v40
    v_and_b32 v40, 0xffff0000, v40
    v_mov_b32 v41, 0
    v_mov_b32 v12, 0
    s_waitcnt vmcnt(8)
    v_dot2c_f32_bf16 v41, v80, v16
    v_dot2c_f32_bf16 v12, v81, v17
    v_dot2c_f32_bf16 v41, v82, v18
    v_dot2c_f32_bf16 v12, v83, v19
    v_dot2c_f32_bf16 v41, v84, v20
    v_dot2c_f32_bf16 v12, v85, v21
    v_dot2c_f32_bf16 v41, v86, v22
    v_dot2c_f32_bf16 v12, v87, v23
    v_dot2c_f32_bf16 v41, v88, v24
    v_dot2c_f32_bf16 v12, v89, v25
    v_dot2c_f32_bf16 v41, v90, v26
    v_dot2c_f32_bf16 v12, v91, v27
    v_dot2c_f32_bf16 v41, v92, v28
    v_dot2c_f32_bf16 v12, v93, v29
    v_dot2c_f32_bf16 v41, v94, v30
    v_dot2c_f32_bf16 v12, v95, v31
    buffer_load_dwordx4 v[80:83], v2, s[44:47], s11 offen offset:0 nt
    buffer_load_dwordx4 v[84:87], v2, s[44:47], s11 offen offset:128 nt
    buffer_load_dwordx4 v[88:91], v2, s[44:47], s11 offen offset:256 nt
    buffer_load_dwordx4 v[92:95], v2, s[44:47], s11 offen offset:384 nt
    s_add_u32 s11, s11, 32768
    v_add_f32 v41, v41, v12
    s_nop 1
    v_add_f32_dpp v41, v41, v41 quad_perm:[1,0,3,2] row_mask:0xf bank_mask:0xf
    s_nop 1
    v_add_f32_dpp v41, v41, v41 quad_perm:[2,3,0,1] row_mask:0xf bank_mask:0xf
    s_nop 1
    v_add_f32_dpp v41, v41, v41 row_half_mirror row_mask:0xf bank_mask:0xf
    v_cvt_pk_bf16_f32 v41, v41, v41
    v_and_b32 v41, 0xffff0000, v41
    v_mov_b32 v42, 0
    v_mov_b32 v12, 0
    s_waitcnt vmcnt(8)
    v_dot2c_f32_bf16 v42, v96, v16
    v_dot2c_f32_bf16 v12, v97, v17
    v_dot2c_f32_bf16 v42, v98, v18
    v_dot2c_f32_bf16 v12, v99, v19
    v_dot2c_f32_bf16 v42, v100, v20
    v_dot2c_f32_bf16 v12, v101, v21
    v_dot2c_f32_bf16 v42, v102, v22
    v_dot2c_f32_bf16 v12, v103, v23
    v_dot2c_f32_bf16 v42, v104, v24
    v_dot2c_f32_bf16 v12, v105, v25
    v_dot2c_f32_bf16 v42, v106, v26
    v_dot2c_f32_bf16 v12, v107, v27
    v_dot2c_f32_bf16 v42, v108, v28
    v_dot2c_f32_bf16 v12, v109, v29
    v_dot2c_f32_bf16 v42, v110, v30
    v_dot2c_f32_bf16 v12, v111, v31
    buffer_load_dwordx4 v[96:99], v2, s[44:47], s11 offen offset:0 nt
    buffer_load_dwordx4 v[100:103], v2, s[44:47], s11 offen offset:128 nt
    buffer_load_dwordx4 v[104:107], v2, s[44:47], s11 offen offset:256 nt
    buffer_load_dwordx4 v[108:111], v2, s[44:47], s11 offen offset:384 nt
    s_add_u32 s11, s11, 32768
    v_add_f32 v42, v42, v12
    s_cmp_lg_u32 s3, 0
    s_cbranch_scc1 L_c2a
    s_waitcnt vmcnt(16)
L_cnt_chka:
    v_readfirstlane_b32 s13, v51
    s_cmp_ge_u32 s13, 256
    s_cbranch_scc1 L_cnt_oka
    buffer_load_dword v51, v50, s[76:79], 0 offen sc1
    s_waitcnt vmcnt(0)
    s_sub_u32 s16, s16, 1
    s_cbranch_scc0 L_cnt_chka
L_cnt_oka:
    v_mov_b32 v50, 0
    v_mov_b32 v51, 1
    ds_write_b32 v50, v51 offset:60928
L_c2a:
    v_add_f32_dpp v42, v42, v42 quad_perm:[1,0,3,2] row_mask:0xf bank_mask:0xf
    s_nop 1
    v_add_f32_dpp v42, v42, v42 quad_perm:[2,3,0,1] row_mask:0xf bank_mask:0xf
    s_nop 1
    v_add_f32_dpp v42, v42, v42 row_half_mirror row_mask:0xf bank_mask:0xf
    v_cvt_pk_bf16_f32 v42, v42, v42
    v_and_b32 v42, 0xffff0000, v42
    v_mov_b32 v43, 0
    v_mov_b32 v12, 0
    s_waitcnt vmcnt(8)
    v_dot2c_f32_bf16 v43, v112, v16
    v_dot2c_f32_bf16 v12, v113, v17
    v_dot2c_f32_bf16 v43, v114, v18
    v_dot2c_f32_bf16 v12, v115, v19
    v_dot2c_f32_bf16 v43, v116, v20
    v_dot2c_f32_bf16 v12, v117, v21
    v_dot2c_f32_bf16 v43, v118, v22
    v_dot2c_f32_bf16 v12, v119, v23
    v_dot2c_f32_bf16 v43, v120, v24
    v_dot2c_f32_bf16 v12, v121, v25
    v_dot2c_f32_bf16 v43, v122, v26
    v_dot2c_f32_bf16 v12, v123, v27
    v_dot2c_f32_bf16 v43, v124, v28
    v_dot2c_f32_bf16 v12, v125, v29
    v_dot2c_f32_bf16 v43, v126, v30
    v_dot2c_f32_bf16 v12, v127, v31
    buffer_load_dwordx4 v[112:115], v2, s[44:47], s11 offen offset:0 nt
    buffer_load_dwordx4 v[116:119], v2, s[44:47], s11 offen offset:128 nt
    buffer_load_dwordx4 v[120:123], v2, s[44:47], s11 offen offset:256 nt
    buffer_load_dwordx4 v[124:127], v2, s[44:47], s11 offen offset:384 nt
    s_add_u32 s11, s11, 32768
    buffer_load_dwordx4 v[144:147], v7, s[56:59], s84 offen offset:0 nt
    buffer_load_dwordx4 v[148:151], v7, s[56:59], s84 offen offset:128 nt
    v_add_f32 v43, v43, v12
    s_nop 1
    v_add_f32_dpp v43, v43, v43 quad_perm:[1,0,3,2] row_mask:0xf bank_mask:0xf
    s_nop 1
    v_add_f32_dpp v43, v43, v43 quad_perm:[2,3,0,1] row_mask:0xf bank_mask:0xf
    s_nop 1
    v_add_f32_dpp v43, v43, v43 row_half_mirror row_mask:0xf bank_mask:0xf
    v_cvt_pk_bf16_f32 v43, v43, v43
    v_and_b32 v43, 0xffff0000, v43
    v_mov_b32 v44, 0
    v_mov_b32 v12, 0
    s_waitcnt vmcnt(10)
    v_dot2c_f32_bf16 v44, v80, v16
    v_dot2c_f32_bf16 v12, v81, v17
    v_dot2c_f32_bf16 v44, v82, v18
    v_dot2c_f32_bf16 v12, v83, v19
    v_dot2c_f32_bf16 v44, v84, v20
    v_dot2c_f32_bf16 v12, v85, v21
    v_dot2c_f32_bf16 v44, v86, v22
    v_dot2c_f32_bf16 v12, v87, v23
    v_dot2c_f32_bf16 v44, v88, v24
    v_dot2c_f32_bf16 v12, v89, v25
    v_dot2c_f32_bf16 v44, v90, v26
    v_dot2c_f32_bf16 v12, v91, v27
    v_dot2c_f32_bf16 v44, v92, v28
    v_dot2c_f32_bf16 v12, v93, v29
    v_dot2c_f32_bf16 v44, v94, v30
    v_dot2c_f32_bf16 v12, v95, v31
    buffer_load_dwordx4 v[80:83], v2, s[44:47], s11 offen offset:0 nt
    buffer_load_dwordx4 v[84:87], v2, s[44:47], s11 offen offset:128 nt
    buffer_load_dwordx4 v[88:91], v2, s[44:47], s11 offen offset:256 nt
    buffer_load_dwordx4 v[92:95], v2, s[44:47], s11 offen offset:384 nt
    s_add_u32 s11, s11, 32768
    buffer_load_dwordx4 v[152:155], v7, s[56:59], s84 offen offset:256 nt
    buffer_load_dwordx4 v[156:159], v7, s[56:59], s84 offen offset:384 nt
    v_add_f32 v44, v44, v12
    s_nop 1
    v_add_f32_dpp v44, v44, v44 quad_perm:[1,0,3,2] row_mask:0xf bank_mask:0xf
    s_nop 1
    v_add_f32_dpp v44, v44, v44 quad_perm:[2,3,0,1] row_mask:0xf bank_mask:0xf
    s_nop 1
    v_add_f32_dpp v44, v44, v44 row_half_mirror row_mask:0xf bank_mask:0xf
    v_cvt_pk_bf16_f32 v44, v44, v44
    v_and_b32 v44, 0xffff0000, v44
    v_mov_b32 v45, 0
    v_mov_b32 v12, 0
    s_waitcnt vmcnt(12)
    v_dot2c_f32_bf16 v45, v96, v16
    v_dot2c_f32_bf16 v12, v97, v17
    v_dot2c_f32_bf16 v45, v98, v18
    v_dot2c_f32_bf16 v12, v99, v19
    v_dot2c_f32_bf16 v45, v100, v20
    v_dot2c_f32_bf16 v12, v101, v21
    v_dot2c_f32_bf16 v45, v102, v22
    v_dot2c_f32_bf16 v12, v103, v23
    v_dot2c_f32_bf16 v45, v104, v24
    v_dot2c_f32_bf16 v12, v105, v25
    v_dot2c_f32_bf16 v45, v106, v26
    v_dot2c_f32_bf16 v12, v107, v27
    v_dot2c_f32_bf16 v45, v108, v28
    v_dot2c_f32_bf16 v12, v109, v29
    v_dot2c_f32_bf16 v45, v110, v30
    v_dot2c_f32_bf16 v12, v111, v31
    buffer_load_dwordx4 v[96:99], v2, s[48:51], s12 offen offset:0 nt
    buffer_load_dwordx4 v[100:103], v2, s[48:51], s12 offen offset:128 nt
    buffer_load_dwordx4 v[104:107], v2, s[48:51], s12 offen offset:256 nt
    buffer_load_dwordx4 v[108:111], v2, s[48:51], s12 offen offset:384 nt
    s_add_u32 s12, s12, 32768
    buffer_load_dwordx4 v[160:163], v7, s[56:59], s84 offen offset:512 nt
    buffer_load_dwordx4 v[164:167], v7, s[56:59], s84 offen offset:640 nt
    v_add_f32 v45, v45, v12
    s_nop 1
    v_add_f32_dpp v45, v45, v45 quad_perm:[1,0,3,2] row_mask:0xf bank_mask:0xf
    s_nop 1
    v_add_f32_dpp v45, v45, v45 quad_perm:[2,3,0,1] row_mask:0xf bank_mask:0xf
    s_nop 1
    v_add_f32_dpp v45, v45, v45 row_half_mirror row_mask:0xf bank_mask:0xf
    v_cvt_pk_bf16_f32 v45, v45, v45
    v_and_b32 v45, 0xffff0000, v45
    v_mov_b32 v46, 0
    v_mov_b32 v12, 0
    s_waitcnt vmcnt(14)
    v_dot2c_f32_bf16 v46, v112, v16
    v_dot2c_f32_bf16 v12, v113, v17
    v_dot2c_f32_bf16 v46, v114, v18
    v_dot2c_f32_bf16 v12, v115, v19
    v_dot2c_f32_bf16 v46, v116, v20
    v_dot2c_f32_bf16 v12, v117, v21
    v_dot2c_f32_bf16 v46, v118, v22
    v_dot2c_f32_bf16 v12, v119, v23
    v_dot2c_f32_bf16 v46, v120, v24
    v_dot2c_f32_bf16 v12, v121, v25
    v_dot2c_f32_bf16 v46, v122, v26
    v_dot2c_f32_bf16 v12, v123, v27
    v_dot2c_f32_bf16 v46, v124, v28
    v_dot2c_f32_bf16 v12, v125, v29
    v_dot2c_f32_bf16 v46, v126, v30
    v_dot2c_f32_bf16 v12, v127, v31
    buffer_load_dwordx4 v[112:115], v2, s[48:51], s12 offen offset:0 nt
    buffer_load_dwordx4 v[116:119], v2, s[48:51], s12 offen offset:128 nt
    buffer_load_dwordx4 v[120:123], v2, s[48:51], s12 offen offset:256 nt
    buffer_load_dwordx4 v[124:127], v2, s[48:51], s12 offen offset:384 nt
    s_add_u32 s12, s12, 32768
    buffer_load_dwordx4 v[168:171], v7, s[56:59], s84 offen offset:768 nt
    buffer_load_dwordx4 v[172:175], v7, s[56:59], s84 offen offset:896 nt
    v_add_f32 v46, v46, v12
    s_nop 1
    v_add_f32_dpp v46, v46, v46 quad_perm:[1,0,3,2] row_mask:0xf bank_mask:0xf
    s_nop 1
    v_add_f32_dpp v46, v46, v46 quad_perm:[2,3,0,1] row_mask:0xf bank_mask:0xf
    s_nop 1
    v_add_f32_dpp v46, v46, v46 row_half_mirror row_mask:0xf bank_mask:0xf
    v_cvt_pk_bf16_f32 v46, v46, v46
    v_and_b32 v46, 0xffff0000, v46
    v_mov_b32 v47, 0
    v_mov_b32 v12, 0
    s_waitcnt vmcnt(14)
    v_dot2c_f32_bf16 v47, v80, v16
    v_dot2c_f32_bf16 v12, v81, v17
    v_dot2c_f32_bf16 v47, v82, v18
    v_dot2c_f32_bf16 v12, v83, v19
    v_dot2c_f32_bf16 v47, v84, v20
    v_dot2c_f32_bf16 v12, v85, v21
    v_dot2c_f32_bf16 v47, v86, v22
    v_dot2c_f32_bf16 v12, v87, v23
    v_dot2c_f32_bf16 v47, v88, v24
    v_dot2c_f32_bf16 v12, v89, v25
    v_dot2c_f32_bf16 v47, v90, v26
    v_dot2c_f32_bf16 v12, v91, v27
    v_dot2c_f32_bf16 v47, v92, v28
    v_dot2c_f32_bf16 v12, v93, v29
    v_dot2c_f32_bf16 v47, v94, v30
    v_dot2c_f32_bf16 v12, v95, v31
    buffer_load_dwordx4 v[80:83], v2, s[48:51], s12 offen offset:0 nt
    buffer_load_dwordx4 v[84:87], v2, s[48:51], s12 offen offset:128 nt
    buffer_load_dwordx4 v[88:91], v2, s[48:51], s12 offen offset:256 nt
    buffer_load_dwordx4 v[92:95], v2, s[48:51], s12 offen offset:384 nt
    s_add_u32 s12, s12, 32768
    buffer_load_dwordx4 v[176:179], v7, s[56:59], s84 offen offset:1024 nt
    buffer_load_dwordx4 v[180:183], v7, s[56:59], s84 offen offset:1152 nt
    v_add_f32 v47, v47, v12
    s_nop 1
    v_add_f32_dpp v47, v47, v47 quad_perm:[1,0,3,2] row_mask:0xf bank_mask:0xf
    s_nop 1
    v_add_f32_dpp v47, v47, v47 quad_perm:[2,3,0,1] row_mask:0xf bank_mask:0xf
    s_nop 1
    v_add_f32_dpp v47, v47, v47 row_half_mirror row_mask:0xf bank_mask:0xf
    v_cvt_pk_bf16_f32 v47, v47, v47
    v_and_b32 v47, 0xffff0000, v47
    v_max3_f32 v12, v32, v33, v34
    v_max3_f32 v12, v12, v35, v36
    v_max3_f32 v12, v12, v37, v38
    v_max3_f32 v12, v12, v39, v40
    v_max3_f32 v12, v12, v41, v42
    v_max3_f32 v12, v12, v43, v44
    v_max3_f32 v12, v12, v45, v46
    v_max_f32 v12, v12, v47
    s_nop 1
    v_max_f32_dpp v12, v12, v12 row_ror:8 row_mask:0xf bank_mask:0xf
    v_mov_b32 v13, v12
    s_nop 1
    v_permlane16_swap_b32 v12, v13
    v_max_f32 v12, v12, v13
    v_mov_b32 v13, v12
    s_nop 1
    v_permlane32_swap_b32 v12, v13
    v_max_f32 v12, v12, v13
    s_mov_b32 s85, 0x3db8aa3b
    v_mul_f32 v12, s85, v12
    v_fma_f32 v32, v32, s85, -v12
    v_fma_f32 v33, v33, s85, -v12
    v_fma_f32 v34, v34, s85, -v12
    v_fma_f32 v35, v35, s85, -v12
    v_fma_f32 v36, v36, s85, -v12
    v_fma_f32 v37, v37, s85, -v12
    v_fma_f32 v38, v38, s85, -v12
    v_fma_f32 v39, v39, s85, -v12
    v_fma_f32 v40, v40, s85, -v12
    v_fma_f32 v41, v41, s85, -v12
    v_fma_f32 v42, v42, s85, -v12
    v_fma_f32 v43, v43, s85, -v12
    v_fma_f32 v44, v44, s85, -v12
    v_fma_f32 v45, v45, s85, -v12
    v_fma_f32 v46, v46, s85, -v12
    v_fma_f32 v47, v47, s85, -v12
    v_exp_f32 v32, v32
    v_exp_f32 v33, v33
    v_exp_f32 v34, v34
    v_exp_f32 v35, v35
    v_exp_f32 v36, v36
    v_exp_f32 v37, v37
    v_exp_f32 v38, v38
    v_exp_f32 v39, v39
    v_exp_f32 v40, v40
    v_exp_f32 v41, v41
    v_exp_f32 v42, v42
    v_exp_f32 v43, v43
    v_exp_f32 v44, v44
    v_exp_f32 v45, v45
    v_exp_f32 v46, v46
    v_exp_f32 v47, v47
    v_add_f32 v13, v32, v33
    v_add_f32 v13, v13, v34
    v_add_f32 v13, v13, v35
    v_add_f32 v13, v13, v36
    v_add_f32 v13, v13, v37
    v_add_f32 v13, v13, v38
    v_add_f32 v13, v13, v39
    v_add_f32 v13, v13, v40
    v_add_f32 v13, v13, v41
    v_add_f32 v13, v13, v42
    v_add_f32 v13, v13, v43
    v_add_f32 v13, v13, v44
    v_add_f32 v13, v13, v45
    v_add_f32 v13, v13, v46
    v_add_f32 v13, v13, v47
    v_cvt_pk_bf16_f32 v32, v32, v32
    v_cvt_pk_bf16_f32 v33, v33, v33
    v_cvt_pk_bf16_f32 v34, v34, v34
    v_cvt_pk_bf16_f32 v35, v35, v35
    v_cvt_pk_bf16_f32 v36, v36, v36
    v_cvt_pk_bf16_f32 v37, v37, v37
    v_cvt_pk_bf16_f32 v38, v38, v38
    v_cvt_pk_bf16_f32 v39, v39, v39
    v_cvt_pk_bf16_f32 v40, v40, v40
    v_cvt_pk_bf16_f32 v41, v41, v41
    v_cvt_pk_bf16_f32 v42, v42, v42
    v_cvt_pk_bf16_f32 v43, v43, v43
    v_cvt_pk_bf16_f32 v44, v44, v44
    v_cvt_pk_bf16_f32 v45, v45, v45
    v_cvt_pk_bf16_f32 v46, v46, v46
    v_cvt_pk_bf16_f32 v47, v47, v47
    v_add_f32_dpp v13, v13, v13 row_ror:8 row_mask:0xf bank_mask:0xf
    v_mov_b32 v14, v13
    s_nop 1
    v_permlane16_swap_b32 v13, v14
    v_add_f32 v13, v13, v14
    v_mov_b32 v14, v13
    s_nop 1
    v_permlane32_swap_b32 v13, v14
    v_add_f32 v13, v13, v14
    v_min_u32 v12, -2, v12
    v_min_u32 v13, -2, v13
    v_mov_b32 v14, 0
    s_mov_b32 s16, 0x186a00
L_lca:
    ds_read_b32 v15, v14 offset:60928
    s_waitcnt lgkmcnt(0)
    v_readfirstlane_b32 s13, v15
    s_cmp_lg_u32 s13, 0
    s_cbranch_scc1 L_lc_oka
    s_sub_u32 s16, s16, 1
    s_cbranch_scc0 L_lca
L_lc_oka:
    buffer_store_dwordx2 v[12:13], v79, s[80:83], 0 offen sc1
    v_mov_b32 v60, 0
    v_mov_b32 v61, 0
    v_mov_b32 v62, 0
    v_mov_b32 v63, 0
    v_mov_b32 v64, 0
    v_mov_b32 v65, 0
    v_mov_b32 v66, 0
    v_mov_b32 v67, 0
    v_mov_b32 v68, 0
    v_mov_b32 v69, 0
    v_mov_b32 v70, 0
    v_mov_b32 v71, 0
    v_mov_b32 v72, 0
    v_mov_b32 v73, 0
    v_mov_b32 v74, 0
    v_mov_b32 v75, 0
    s_setprio 1
    v_and_b32 v52, v32, v3
    v_and_b32 v53, v32, v4
    v_and_b32 v54, v32, v5
    v_and_b32 v55, v32, v6
    s_waitcnt vmcnt(15)
    s_nop 0
    v_mfma_f32_16x16x32_bf16 v[60:63], v[52:55], v[96:99], v[60:63]
    v_mfma_f32_16x16x32_bf16 v[64:67], v[52:55], v[100:103], v[64:67]
    v_mfma_f32_16x16x32_bf16 v[68:71], v[52:55], v[104:107], v[68:71]
    v_mfma_f32_16x16x32_bf16 v[72:75], v[52:55], v[108:111], v[72:75]
    buffer_load_dwordx4 v[96:99], v2, s[48:51], s12 offen offset:0 nt
    buffer_load_dwordx4 v[100:103], v2, s[48:51], s12 offen offset:128 nt
    buffer_load_dwordx4 v[104:107], v2, s[48:51], s12 offen offset:256 nt
    buffer_load_dwordx4 v[108:111], v2, s[48:51], s12 offen offset:384 nt
    s_add_u32 s12, s12, 32768
    buffer_load_dwordx4 v[184:187], v7, s[56:59], s84 offen offset:1280 nt
    buffer_load_dwordx4 v[188:191], v7, s[56:59], s84 offen offset:1408 nt
    v_and_b32 v56, v33, v3
    v_and_b32 v57, v33, v4
    v_and_b32 v58, v33, v5
    v_and_b32 v59, v33, v6
    s_waitcnt vmcnt(15)
    s_nop 0
    v_mfma_f32_16x16x32_bf16 v[60:63], v[56:59], v[112:115], v[60:63]
    v_mfma_f32_16x16x32_bf16 v[64:67], v[56:59], v[116:119], v[64:67]
    v_mfma_f32_16x16x32_bf16 v[68:71], v[56:59], v[120:123], v[68:71]
    v_mfma_f32_16x16x32_bf16 v[72:75], v[56:59], v[124:127], v[72:75]
    buffer_load_dwordx4 v[112:115], v2, s[48:51], s12 offen offset:0 nt
    buffer_load_dwordx4 v[116:119], v2, s[48:51], s12 offen offset:128 nt
    buffer_load_dwordx4 v[120:123], v2, s[48:51], s12 offen offset:256 nt
    buffer_load_dwordx4 v[124:127], v2, s[48:51], s12 offen offset:384 nt
    s_add_u32 s12, s12, 32768
    buffer_load_dwordx4 v[192:195], v7, s[56:59], s84 offen offset:1536 nt
    buffer_load_dwordx4 v[196:199], v7, s[56:59], s84 offen offset:1664 nt
    v_and_b32 v52, v34, v3
    v_and_b32 v53, v34, v4
    v_and_b32 v54, v34, v5
    v_and_b32 v55, v34, v6
    s_waitcnt vmcnt(15)
    s_nop 0
    v_mfma_f32_16x16x32_bf16 v[60:63], v[52:55], v[80:83], v[60:63]
    v_mfma_f32_16x16x32_bf16 v[64:67], v[52:55], v[84:87], v[64:67]
    v_mfma_f32_16x16x32_bf16 v[68:71], v[52:55], v[88:91], v[68:71]
    v_mfma_f32_16x16x32_bf16 v[72:75], v[52:55], v[92:95], v[72:75]
    buffer_load_dwordx4 v[80:83], v2, s[48:51], s12 offen offset:0 nt
    buffer_load_dwordx4 v[84:87], v2, s[48:51], s12 offen offset:128 nt
    buffer_load_dwordx4 v[88:91], v2, s[48:51], s12 offen offset:256 nt
    buffer_load_dwordx4 v[92:95], v2, s[48:51], s12 offen offset:384 nt
    s_add_u32 s12, s12, 32768
    buffer_load_dwordx4 v[200:203], v7, s[56:59], s84 offen offset:1792 nt
    buffer_load_dwordx4 v[204:207], v7, s[56:59], s84 offen offset:1920 nt
    v_and_b32 v56, v35, v3
    v_and_b32 v57, v35, v4
    v_and_b32 v58, v35, v5
    v_and_b32 v59, v35, v6
    s_waitcnt vmcnt(14)
    s_nop 0
    v_mfma_f32_16x16x32_bf16 v[60:63], v[56:59], v[96:99], v[60:63]
    v_mfma_f32_16x16x32_bf16 v[64:67], v[56:59], v[100:103], v[64:67]
    v_mfma_f32_16x16x32_bf16 v[68:71], v[56:59], v[104:107], v[68:71]
    v_mfma_f32_16x16x32_bf16 v[72:75], v[56:59], v[108:111], v[72:75]
    buffer_load_dwordx4 v[96:99], v2, s[48:51], s12 offen offset:0 nt
    buffer_load_dwordx4 v[100:103], v2, s[48:51], s12 offen offset:128 nt
    buffer_load_dwordx4 v[104:107], v2, s[48:51], s12 offen offset:256 nt
    buffer_load_dwordx4 v[108:111], v2, s[48:51], s12 offen offset:384 nt
    s_add_u32 s12, s12, 32768
    buffer_load_dwordx4 v[208:211], v7, s[56:59], s84 offen offset:2048 nt
    buffer_load_dwordx4 v[212:215], v7, s[56:59], s84 offen offset:2176 nt
    v_and_b32 v52, v36, v3
    v_and_b32 v53, v36, v4
    v_and_b32 v54, v36, v5
    v_and_b32 v55, v36, v6
    s_waitcnt vmcnt(14)
    s_nop 0
    v_mfma_f32_16x16x32_bf16 v[60:63], v[52:55], v[112:115], v[60:63]
    v_mfma_f32_16x16x32_bf16 v[64:67], v[52:55], v[116:119], v[64:67]
    v_mfma_f32_16x16x32_bf16 v[68:71], v[52:55], v[120:123], v[68:71]
    v_mfma_f32_16x16x32_bf16 v[72:75], v[52:55], v[124:127], v[72:75]
    buffer_load_dwordx4 v[112:115], v2, s[48:51], s12 offen offset:0 nt
    buffer_load_dwordx4 v[116:119], v2, s[48:51], s12 offen offset:128 nt
    buffer_load_dwordx4 v[120:123], v2, s[48:51], s12 offen offset:256 nt
    buffer_load_dwordx4 v[124:127], v2, s[48:51], s12 offen offset:384 nt
    s_add_u32 s12, s12, 32768
    buffer_load_dwordx4 v[216:219], v7, s[56:59], s84 offen offset:2304 nt
    buffer_load_dwordx4 v[220:223], v7, s[56:59], s84 offen offset:2432 nt
    v_and_b32 v56, v37, v3
    v_and_b32 v57, v37, v4
    v_and_b32 v58, v37, v5
    v_and_b32 v59, v37, v6
    s_waitcnt vmcnt(14)
    s_nop 0
    v_mfma_f32_16x16x32_bf16 v[60:63], v[56:59], v[80:83], v[60:63]
    v_mfma_f32_16x16x32_bf16 v[64:67], v[56:59], v[84:87], v[64:67]
    v_mfma_f32_16x16x32_bf16 v[68:71], v[56:59], v[88:91], v[68:71]
    v_mfma_f32_16x16x32_bf16 v[72:75], v[56:59], v[92:95], v[72:75]
    buffer_load_dwordx4 v[80:83], v2, s[48:51], s12 offen offset:0 nt
    buffer_load_dwordx4 v[84:87], v2, s[48:51], s12 offen offset:128 nt
    buffer_load_dwordx4 v[88:91], v2, s[48:51], s12 offen offset:256 nt
    buffer_load_dwordx4 v[92:95], v2, s[48:51], s12 offen offset:384 nt
    s_add_u32 s12, s12, 32768
    buffer_load_dwordx4 v[224:227], v7, s[56:59], s84 offen offset:2560 nt
    buffer_load_dwordx4 v[228:231], v7, s[56:59], s84 offen offset:2688 nt
    v_and_b32 v52, v38, v3
    v_and_b32 v53, v38, v4
    v_and_b32 v54, v38, v5
    v_and_b32 v55, v38, v6
    s_waitcnt vmcnt(14)
    s_nop 0
    v_mfma_f32_16x16x32_bf16 v[60:63], v[52:55], v[96:99], v[60:63]
    v_mfma_f32_16x16x32_bf16 v[64:67], v[52:55], v[100:103], v[64:67]
    v_mfma_f32_16x16x32_bf16 v[68:71], v[52:55], v[104:107], v[68:71]
    v_mfma_f32_16x16x32_bf16 v[72:75], v[52:55], v[108:111], v[72:75]
    buffer_load_dwordx4 v[96:99], v2, s[48:51], s12 offen offset:0 nt
    buffer_load_dwordx4 v[100:103], v2, s[48:51], s12 offen offset:128 nt
    buffer_load_dwordx4 v[104:107], v2, s[48:51], s12 offen offset:256 nt
    buffer_load_dwordx4 v[108:111], v2, s[48:51], s12 offen offset:384 nt
    s_add_u32 s12, s12, 32768
    buffer_load_dwordx4 v[232:235], v7, s[56:59], s84 offen offset:2816 nt
    buffer_load_dwordx4 v[236:239], v7, s[56:59], s84 offen offset:2944 nt
    v_and_b32 v56, v39, v3
    v_and_b32 v57, v39, v4
    v_and_b32 v58, v39, v5
    v_and_b32 v59, v39, v6
    s_waitcnt vmcnt(14)
    s_nop 0
    v_mfma_f32_16x16x32_bf16 v[60:63], v[56:59], v[112:115], v[60:63]
    v_mfma_f32_16x16x32_bf16 v[64:67], v[56:59], v[116:119], v[64:67]
    v_mfma_f32_16x16x32_bf16 v[68:71], v[56:59], v[120:123], v[68:71]
    v_mfma_f32_16x16x32_bf16 v[72:75], v[56:59], v[124:127], v[72:75]
    buffer_load_dwordx4 v[112:115], v2, s[48:51], s12 offen offset:0 nt
    buffer_load_dwordx4 v[116:119], v2, s[48:51], s12 offen offset:128 nt
    buffer_load_dwordx4 v[120:123], v2, s[48:51], s12 offen offset:256 nt
    buffer_load_dwordx4 v[124:127], v2, s[48:51], s12 offen offset:384 nt
    s_add_u32 s12, s12, 32768
    buffer_load_dwordx4 v[240:243], v7, s[56:59], s84 offen offset:3072 nt
    buffer_load_dwordx4 v[244:247], v7, s[56:59], s84 offen offset:3200 nt
    s_setprio 0
    v_and_b32 v52, v40, v3
    v_and_b32 v53, v40, v4
    v_and_b32 v54, v40, v5
    v_and_b32 v55, v40, v6
    s_waitcnt vmcnt(14)
    s_nop 0
    v_mfma_f32_16x16x32_bf16 v[60:63], v[52:55], v[80:83], v[60:63]
    v_mfma_f32_16x16x32_bf16 v[64:67], v[52:55], v[84:87], v[64:67]
    v_mfma_f32_16x16x32_bf16 v[68:71], v[52:55], v[88:91], v[68:71]
    v_mfma_f32_16x16x32_bf16 v[72:75], v[52:55], v[92:95], v[72:75]
    buffer_load_dwordx4 v[80:83], v2, s[48:51], s12 offen offset:0 nt
    buffer_load_dwordx4 v[84:87], v2, s[48:51], s12 offen offset:128 nt
    buffer_load_dwordx4 v[88:91], v2, s[48:51], s12 offen offset:256 nt
    buffer_load_dwordx4 v[92:95], v2, s[48:51], s12 offen offset:384 nt
    s_add_u32 s12, s12, 32768
    buffer_load_dwordx4 v[248:251], v7, s[56:59], s84 offen offset:3328 nt
    buffer_load_dwordx4 v[252:255], v7, s[56:59], s84 offen offset:3456 nt
    v_and_b32 v56, v41, v3
    v_and_b32 v57, v41, v4
    v_and_b32 v58, v41, v5
    v_and_b32 v59, v41, v6
    s_waitcnt vmcnt(14)
    s_nop 0
    v_mfma_f32_16x16x32_bf16 v[60:63], v[56:59], v[96:99], v[60:63]
    v_mfma_f32_16x16x32_bf16 v[64:67], v[56:59], v[100:103], v[64:67]
    v_mfma_f32_16x16x32_bf16 v[68:71], v[56:59], v[104:107], v[68:71]
    v_mfma_f32_16x16x32_bf16 v[72:75], v[56:59], v[108:111], v[72:75]
    buffer_load_dwordx4 v[96:99], v2, s[48:51], s12 offen offset:0 nt
    buffer_load_dwordx4 v[100:103], v2, s[48:51], s12 offen offset:128 nt
    buffer_load_dwordx4 v[104:107], v2, s[48:51], s12 offen offset:256 nt
    buffer_load_dwordx4 v[108:111], v2, s[48:51], s12 offen offset:384 nt
    s_add_u32 s12, s12, 32768
    v_and_b32 v52, v42, v3
    v_and_b32 v53, v42, v4
    v_and_b32 v54, v42, v5
    v_and_b32 v55, v42, v6
    s_waitcnt vmcnt(12)
    s_nop 0
    v_mfma_f32_16x16x32_bf16 v[60:63], v[52:55], v[112:115], v[60:63]
    v_mfma_f32_16x16x32_bf16 v[64:67], v[52:55], v[116:119], v[64:67]
    v_mfma_f32_16x16x32_bf16 v[68:71], v[52:55], v[120:123], v[68:71]
    v_mfma_f32_16x16x32_bf16 v[72:75], v[52:55], v[124:127], v[72:75]
    buffer_load_dwordx4 v[112:115], v2, s[48:51], s12 offen offset:0 nt
    buffer_load_dwordx4 v[116:119], v2, s[48:51], s12 offen offset:128 nt
    buffer_load_dwordx4 v[120:123], v2, s[48:51], s12 offen offset:256 nt
    buffer_load_dwordx4 v[124:127], v2, s[48:51], s12 offen offset:384 nt
    s_add_u32 s12, s12, 32768
    s_lshl_b32 s13, s5, 4
    s_add_u32 s13, s13, s4
    s_lshl_b32 s13, s13, 8
    s_lshl_b32 s14, s7, 1
    s_add_u32 s14, s14, s6
    s_lshl_b32 s14, s14, 6
    s_add_u32 s14, s14, s13
    v_and_b32 v12, 31, v1
    v_lshlrev_b32 v12, 3, v12
    v_and_b32 v13, 7, v1
    v_lshlrev_b32 v13, 3, v13
    buffer_load_dwordx2 v[16:17], v12, s[80:83], s13 offen sc1
    buffer_load_dwordx2 v[18:19], v13, s[80:83], s14 offen sc1
    v_and_b32 v56, v43, v3
    v_and_b32 v57, v43, v4
    v_and_b32 v58, v43, v5
    v_and_b32 v59, v43, v6
    s_waitcnt vmcnt(12)
    s_nop 0
    v_mfma_f32_16x16x32_bf16 v[60:63], v[56:59], v[80:83], v[60:63]
    v_mfma_f32_16x16x32_bf16 v[64:67], v[56:59], v[84:87], v[64:67]
    v_mfma_f32_16x16x32_bf16 v[68:71], v[56:59], v[88:91], v[68:71]
    v_mfma_f32_16x16x32_bf16 v[72:75], v[56:59], v[92:95], v[72:75]
    buffer_load_dwordx4 v[80:83], v2, s[48:51], s12 offen offset:0 nt
    buffer_load_dwordx4 v[84:87], v2, s[48:51], s12 offen offset:128 nt
    buffer_load_dwordx4 v[88:91], v2, s[48:51], s12 offen offset:256 nt
    buffer_load_dwordx4 v[92:95], v2, s[48:51], s12 offen offset:384 nt
    s_add_u32 s12, s12, 32768
    s_and_b32 s85, s2, 1
    s_lshl_b32 s85, s85, 8
    s_add_u32 s85, s85, 24576
    s_cmp_eq_u32 s3, 7
    s_cselect_b32 s85, s85, 0x40000000
    v_mov_b32 v51, s85
    v_mov_b32 v49, 1
    s_mov_b64 exec, 1
    s_lshl_b32 s85, s5, 8
    s_add_u32 s85, s85, 26624
    s_cmp_eq_u32 s3, 7
    s_cselect_b32 s85, s85, 0x40000000
    s_mov_b64 exec, 2
    v_mov_b32 v51, s85
    s_mov_b64 exec, 3
    buffer_atomic_add v49, v51, s[80:83], 0 offen sc0 sc1
    s_mov_b64 exec, -1
    v_and_b32 v52, v44, v3
    v_and_b32 v53, v44, v4
    v_and_b32 v54, v44, v5
    v_and_b32 v55, v44, v6
    s_waitcnt vmcnt(11)
    s_nop 0
    v_mfma_f32_16x16x32_bf16 v[60:63], v[52:55], v[96:99], v[60:63]
    v_mfma_f32_16x16x32_bf16 v[64:67], v[52:55], v[100:103], v[64:67]
    v_mfma_f32_16x16x32_bf16 v[68:71], v[52:55], v[104:107], v[68:71]
    v_mfma_f32_16x16x32_bf16 v[72:75], v[52:55], v[108:111], v[72:75]
    buffer_load_dwordx4 v[96:99], v2, s[48:51], s12 offen offset:0 nt
    buffer_load_dwordx4 v[100:103], v2, s[48:51], s12 offen offset:128 nt
    buffer_load_dwordx4 v[104:107], v2, s[48:51], s12 offen offset:256 nt
    buffer_load_dwordx4 v[108:111], v2, s[48:51], s12 offen offset:384 nt
    s_add_u32 s12, s12, 32768
    v_and_b32 v56, v45, v3
    v_and_b32 v57, v45, v4
    v_and_b32 v58, v45, v5
    v_and_b32 v59, v45, v6
    s_waitcnt vmcnt(11)
    s_nop 0
    v_mfma_f32_16x16x32_bf16 v[60:63], v[56:59], v[112:115], v[60:63]
    v_mfma_f32_16x16x32_bf16 v[64:67], v[56:59], v[116:119], v[64:67]
    v_mfma_f32_16x16x32_bf16 v[68:71], v[56:59], v[120:123], v[68:71]
    v_mfma_f32_16x16x32_bf16 v[72:75], v[56:59], v[124:127], v[72:75]
    v_and_b32 v52, v46, v3
    v_and_b32 v53, v46, v4
    v_and_b32 v54, v46, v5
    v_and_b32 v55, v46, v6
    s_waitcnt vmcnt(5)
    s_nop 0
    v_mfma_f32_16x16x32_bf16 v[60:63], v[52:55], v[80:83], v[60:63]
    v_mfma_f32_16x16x32_bf16 v[64:67], v[52:55], v[84:87], v[64:67]
    v_mfma_f32_16x16x32_bf16 v[68:71], v[52:55], v[88:91], v[68:71]
    v_mfma_f32_16x16x32_bf16 v[72:75], v[52:55], v[92:95], v[72:75]
    s_waitcnt vmcnt(9)
    s_mov_b32 s16, 0x30d40
L_ml_chka:
    v_max3_u32 v14, v16, v17, v18
    v_max_u32 v14, v14, v19
    v_cmp_eq_u32 vcc, -1, v14
    s_cbranch_vccz L_ml_oka
    buffer_load_dwordx2 v[16:17], v12, s[80:83], s13 offen sc1
    buffer_load_dwordx2 v[18:19], v13, s[80:83], s14 offen sc1
    s_waitcnt vmcnt(0)
    s_sub_u32 s16, s16, 1
    s_cbranch_scc0 L_ml_chka
L_ml_oka:
    v_mov_b32 v14, v16
    s_nop 1
    v_max_f32_dpp v14, v14, v14 quad_perm:[1,0,3,2] row_mask:0xf bank_mask:0xf
    s_nop 1
    v_max_f32_dpp v14, v14, v14 quad_perm:[2,3,0,1] row_mask:0xf bank_mask:0xf
    s_nop 1
    v_max_f32_dpp v14, v14, v14 row_half_mirror row_mask:0xf bank_mask:0xf
    s_nop 1
    v_max_f32_dpp v14, v14, v14 row_mirror row_mask:0xf bank_mask:0xf
    v_mov_b32 v50, v14
    s_nop 1
    v_permlane16_swap_b32 v14, v50
    v_max_f32 v14, v14, v50
    v_sub_f32 v16, v16, v14
    v_sub_f32 v18, v18, v14
    v_exp_f32 v16, v16
    v_exp_f32 v18, v18
    v_mul_f32 v16, v16, v17
    s_nop 1
    v_add_f32_dpp v16, v16, v16 quad_perm:[1,0,3,2] row_mask:0xf bank_mask:0xf
    s_nop 1
    v_add_f32_dpp v16, v16, v16 quad_perm:[2,3,0,1] row_mask:0xf bank_mask:0xf
    s_nop 1
    v_add_f32_dpp v16, v16, v16 row_half_mirror row_mask:0xf bank_mask:0xf
    s_nop 1
    v_add_f32_dpp v16, v16, v16 row_mirror row_mask:0xf bank_mask:0xf
    v_mov_b32 v50, v16
    s_nop 1
    v_permlane16_swap_b32 v16, v50
    v_add_f32 v16, v16, v50
    v_rcp_f32 v16, v16
    s_nop 0
    v_mul_f32 v50, v18, v16
    v_and_b32 v56, v47, v3
    v_and_b32 v57, v47, v4
    v_and_b32 v58, v47, v5
    v_and_b32 v59, v47, v6
    s_waitcnt vmcnt(0)
    s_nop 0
    v_mfma_f32_16x16x32_bf16 v[60:63], v[56:59], v[96:99], v[60:63]
    v_mfma_f32_16x16x32_bf16 v[64:67], v[56:59], v[100:103], v[64:67]
    v_mfma_f32_16x16x32_bf16 v[68:71], v[56:59], v[104:107], v[68:71]
    v_mfma_f32_16x16x32_bf16 v[72:75], v[56:59], v[108:111], v[72:75]
    s_mov_b32 exec_lo, 0x00ff00ff
    s_mov_b32 exec_hi, 0xff00ff00
    s_nop 2
    ds_write_b128 v8, v[60:63] offset:0
    ds_write_b128 v8, v[64:67] offset:256
    ds_write_b128 v8, v[68:71] offset:512
    ds_write_b128 v8, v[72:75] offset:768
    s_mov_b64 exec, 3
    v_lshlrev_b32 v51, 2, v1
    s_cmp_eq_u32 s3, 7
    s_cselect_b64 exec, 3, 0
    s_waitcnt vmcnt(4)
    ds_write_b32 v51, v49 offset:60932
    s_mov_b64 exec, -1
    s_waitcnt lgkmcnt(0)
    s_barrier
    ds_read_b128 v[60:63], v9 offset:0
    ds_read_b128 v[64:67], v9 offset:14592
    v_mov_b32 v51, 0
    ds_read_b32 v49, v51 offset:60932
    ds_read_b32 v78, v51 offset:60936
    v_and_b32 v12, 3, v0
    v_mul_u32_u24 v12, 1824, v12
    v_lshrrev_b32 v13, 2, v0
    v_lshl_add_u32 v12, v13, 4, v12
    s_waitcnt lgkmcnt(0)
    v_add_f32 v60, v60, v64
    v_add_f32 v61, v61, v65
    v_add_f32 v62, v62, v66
    v_add_f32 v63, v63, v67
    v_mul_f32 v60, v60, v50
    v_mul_f32 v61, v61, v50
    v_mul_f32 v62, v62, v50
    v_mul_f32 v63, v63, v50
    v_add_f32_dpp v60, v60, v60 quad_perm:[1,0,3,2] row_mask:0xf bank_mask:0xf
    v_add_f32_dpp v61, v61, v61 quad_perm:[1,0,3,2] row_mask:0xf bank_mask:0xf
    v_add_f32_dpp v62, v62, v62 quad_perm:[1,0,3,2] row_mask:0xf bank_mask:0xf
    v_add_f32_dpp v63, v63, v63 quad_perm:[1,0,3,2] row_mask:0xf bank_mask:0xf
    v_add_f32_dpp v60, v60, v60 quad_perm:[2,3,0,1] row_mask:0xf bank_mask:0xf
    v_add_f32_dpp v61, v61, v61 quad_perm:[2,3,0,1] row_mask:0xf bank_mask:0xf
    v_add_f32_dpp v62, v62, v62 quad_perm:[2,3,0,1] row_mask:0xf bank_mask:0xf
    v_add_f32_dpp v63, v63, v63 quad_perm:[2,3,0,1] row_mask:0xf bank_mask:0xf
    v_add_f32_dpp v60, v60, v60 row_half_mirror row_mask:0xf bank_mask:0xf
    v_add_f32_dpp v61, v61, v61 row_half_mirror row_mask:0xf bank_mask:0xf
    v_add_f32_dpp v62, v62, v62 row_half_mirror row_mask:0xf bank_mask:0xf
    v_add_f32_dpp v63, v63, v63 row_half_mirror row_mask:0xf bank_mask:0xf
    v_cvt_pk_bf16_f32 v60, v60, v60
    v_cvt_pk_bf16_f32 v61, v61, v61
    v_cvt_pk_bf16_f32 v62, v62, v62
    v_cvt_pk_bf16_f32 v63, v63, v63
    s_waitcnt vmcnt(19)
    v_and_b32 v52, v60, v3
    v_and_b32 v53, v60, v4
    v_and_b32 v54, v60, v5
    v_and_b32 v55, v60, v6
    s_nop 1
    v_mfma_f32_16x16x32_bf16 v[16:19], v[52:55], v[144:147], 0
    v_mfma_f32_16x16x32_bf16 v[20:23], v[52:55], v[148:151], 0
    v_mfma_f32_16x16x32_bf16 v[24:27], v[52:55], v[152:155], 0
    v_mfma_f32_16x16x32_bf16 v[28:31], v[52:55], v[156:159], 0
    v_mfma_f32_16x16x32_bf16 v[32:35], v[52:55], v[160:163], 0
    v_mfma_f32_16x16x32_bf16 v[36:39], v[52:55], v[164:167], 0
    v_mfma_f32_16x16x32_bf16 v[40:43], v[52:55], v[168:171], 0
    v_and_b32 v56, v61, v3
    v_and_b32 v57, v61, v4
    v_and_b32 v58, v61, v5
    v_and_b32 v59, v61, v6
    s_nop 1
    v_mfma_f32_16x16x32_bf16 v[16:19], v[56:59], v[172:175], v[16:19]
    v_mfma_f32_16x16x32_bf16 v[20:23], v[56:59], v[176:179], v[20:23]
    v_mfma_f32_16x16x32_bf16 v[24:27], v[56:59], v[180:183], v[24:27]
    v_mfma_f32_16x16x32_bf16 v[28:31], v[56:59], v[184:187], v[28:31]
    v_mfma_f32_16x16x32_bf16 v[32:35], v[56:59], v[188:191], v[32:35]
    v_mfma_f32_16x16x32_bf16 v[36:39], v[56:59], v[192:195], v[36:39]
    v_mfma_f32_16x16x32_bf16 v[40:43], v[56:59], v[196:199], v[40:43]
    v_and_b32 v52, v62, v3
    v_and_b32 v53, v62, v4
    v_and_b32 v54, v62, v5
    v_and_b32 v55, v62, v6
    s_nop 1
    v_mfma_f32_16x16x32_bf16 v[16:19], v[52:55], v[200:203], v[16:19]
    v_mfma_f32_16x16x32_bf16 v[20:23], v[52:55], v[204:207], v[20:23]
    v_mfma_f32_16x16x32_bf16 v[24:27], v[52:55], v[208:211], v[24:27]
    v_mfma_f32_16x16x32_bf16 v[28:31], v[52:55], v[212:215], v[28:31]
    v_mfma_f32_16x16x32_bf16 v[32:35], v[52:55], v[216:219], v[32:35]
    v_mfma_f32_16x16x32_bf16 v[36:39], v[52:55], v[220:223], v[36:39]
    v_mfma_f32_16x16x32_bf16 v[40:43], v[52:55], v[224:227], v[40:43]
    v_and_b32 v56, v63, v3
    v_and_b32 v57, v63, v4
    v_and_b32 v58, v63, v5
    v_and_b32 v59, v63, v6
    s_nop 1
    v_mfma_f32_16x16x32_bf16 v[16:19], v[56:59], v[228:231], v[16:19]
    v_mfma_f32_16x16x32_bf16 v[20:23], v[56:59], v[232:235], v[20:23]
    v_mfma_f32_16x16x32_bf16 v[24:27], v[56:59], v[236:239], v[24:27]
    v_mfma_f32_16x16x32_bf16 v[28:31], v[56:59], v[240:243], v[28:31]
    v_mfma_f32_16x16x32_bf16 v[32:35], v[56:59], v[244:247], v[32:35]
    v_mfma_f32_16x16x32_bf16 v[36:39], v[56:59], v[248:251], v[36:39]
    v_mfma_f32_16x16x32_bf16 v[40:43], v[56:59], v[252:255], v[40:43]
    v_readfirstlane_b32 s13, v78
    v_and_b32 v13, 0x40000000, v76
    v_lshl_add_u32 v13, v0, 2, v13
    s_add_u32 s13, s13, 1
    s_and_b32 s13, s13, 63
    s_lshl_b32 s14, s5, 3
    s_add_u32 s14, s14, s13
    s_lshl_b32 s14, s14, 11
    s_add_u32 s14, s14, 864256
    s_cmp_ge_u32 s13, 59
    s_cselect_b64 vcc, -1, 0
    s_lshl_b32 s13, s13, 5
    v_add_u32 v13, s14, v13
    v_add_u32 v76, s13, v76
    v_cndmask_b32 v76, v76, v13, vcc
    s_mov_b32 exec_lo, 0x00ff00ff
    s_mov_b32 exec_hi, 0xff00ff00
    ds_write_b128 v8, v[16:19] offset:29184
    ds_write_b128 v8, v[20:23] offset:29440
    ds_write_b128 v8, v[24:27] offset:29696
    ds_write_b128 v8, v[28:31] offset:29952
    ds_write_b128 v8, v[32:35] offset:30208
    ds_write_b128 v8, v[36:39] offset:30464
    ds_write_b128 v8, v[40:43] offset:30720
    s_mov_b64 exec, -1
    s_waitcnt lgkmcnt(0)
    s_barrier
    s_cmp_eq_u32 s3, 7
    s_cbranch_scc1 L_reda
    ds_read_b128 v[60:63], v12 offset:29184
    ds_read_b128 v[64:67], v12 offset:36480
    ds_read_b128 v[68:71], v12 offset:43776
    ds_read_b128 v[72:75], v12 offset:51072
    s_waitcnt lgkmcnt(2)
    v_add_f32 v60, v60, v64
    v_add_f32 v61, v61, v65
    v_add_f32 v62, v62, v66
    v_add_f32 v63, v63, v67
    s_waitcnt lgkmcnt(0)
    v_add_f32 v68, v68, v72
    v_add_f32 v69, v69, v73
    v_add_f32 v70, v70, v74
    v_add_f32 v71, v71, v75
    v_add_f32 v60, v60, v68
    v_add_f32 v61, v61, v69
    v_add_f32 v62, v62, v70
    v_add_f32 v63, v63, v71
    v_add_f32_dpp v60, v60, v60 quad_perm:[1,0,3,2] row_mask:0xf bank_mask:0xf
    v_add_f32_dpp v61, v61, v61 quad_perm:[1,0,3,2] row_mask:0xf bank_mask:0xf
    v_add_f32_dpp v62, v62, v62 quad_perm:[1,0,3,2] row_mask:0xf bank_mask:0xf
    v_add_f32_dpp v63, v63, v63 quad_perm:[1,0,3,2] row_mask:0xf bank_mask:0xf
    v_add_f32_dpp v60, v60, v60 quad_perm:[2,3,0,1] row_mask:0xf bank_mask:0xf
    v_add_f32_dpp v61, v61, v61 quad_perm:[2,3,0,1] row_mask:0xf bank_mask:0xf
    v_add_f32_dpp v62, v62, v62 quad_perm:[2,3,0,1] row_mask:0xf bank_mask:0xf
    v_add_f32_dpp v63, v63, v63 quad_perm:[2,3,0,1] row_mask:0xf bank_mask:0xf
    v_min_u32 v60, -2, v60
    v_min_u32 v61, -2, v61
    v_min_u32 v62, -2, v62
    v_min_u32 v63, -2, v63
    buffer_store_dwordx4 v[60:63], v76, s[80:83], 0 offen sc1
    v_readfirstlane_b32 s13, v49
    s_add_u32 s13, s13, 1
    s_cmp_ge_u32 s13, 112
    s_cbranch_scc1 L_fina
    s_mov_b32 s10, 1
    s_and_b32 s9, s13, 3
    s_lshr_b32 s13, s13, 2
    s_and_b32 s8, s2, 1
    s_mul_i32 s8, s8, 28
    s_add_u32 s8, s8, s13
    s_mul_i32 s15, s3, 229376
    s_lshl_b32 s85, s8, 6
    s_add_u32 s11, s15, s85
    v_and_b32 v15, 0xffffffbf, v7
    s_mov_b32 exec_lo, 0x0f0f0f0f
    s_mov_b32 exec_hi, 0x0f0f0f0f
    buffer_load_dwordx4 v[80:83], v15, s[60:63], s11 offen
    s_mov_b32 exec_lo, 0xf0f0f0f0
    s_mov_b32 exec_hi, 0xf0f0f0f0
    buffer_load_dwordx4 v[80:83], v15, s[64:67], s11 offen
    s_add_u32 s11, s11, 28672
    s_mov_b32 exec_lo, 0x0f0f0f0f
    s_mov_b32 exec_hi, 0x0f0f0f0f
    buffer_load_dwordx4 v[84:87], v15, s[60:63], s11 offen
    s_mov_b32 exec_lo, 0xf0f0f0f0
    s_mov_b32 exec_hi, 0xf0f0f0f0
    buffer_load_dwordx4 v[84:87], v15, s[64:67], s11 offen
    s_add_u32 s11, s11, 28672
    s_mov_b32 exec_lo, 0x0f0f0f0f
    s_mov_b32 exec_hi, 0x0f0f0f0f
    buffer_load_dwordx4 v[88:91], v15, s[60:63], s11 offen
    s_mov_b32 exec_lo, 0xf0f0f0f0
    s_mov_b32 exec_hi, 0xf0f0f0f0
    buffer_load_dwordx4 v[88:91], v15, s[64:67], s11 offen
    s_add_u32 s11, s11, 28672
    s_mov_b32 exec_lo, 0x0f0f0f0f
    s_mov_b32 exec_hi, 0x0f0f0f0f
    buffer_load_dwordx4 v[92:95], v15, s[60:63], s11 offen
    s_mov_b32 exec_lo, 0xf0f0f0f0
    s_mov_b32 exec_hi, 0xf0f0f0f0
    buffer_load_dwordx4 v[92:95], v15, s[64:67], s11 offen
    s_add_u32 s11, s11, 28672
    s_mov_b32 exec_lo, 0x0f0f0f0f
    s_mov_b32 exec_hi, 0x0f0f0f0f
    buffer_load_dwordx4 v[96:99], v15, s[60:63], s11 offen
    s_mov_b32 exec_lo, 0xf0f0f0f0
    s_mov_b32 exec_hi, 0xf0f0f0f0
    buffer_load_dwordx4 v[96:99], v15, s[64:67], s11 offen
    s_add_u32 s11, s11, 28672
    s_mov_b32 exec_lo, 0x0f0f0f0f
    s_mov_b32 exec_hi, 0x0f0f0f0f
    buffer_load_dwordx4 v[100:103], v15, s[60:63], s11 offen
    s_mov_b32 exec_lo, 0xf0f0f0f0
    s_mov_b32 exec_hi, 0xf0f0f0f0
    buffer_load_dwordx4 v[100:103], v15, s[64:67], s11 offen
    s_add_u32 s11, s11, 28672
    s_mov_b32 exec_lo, 0x0f0f0f0f
    s_mov_b32 exec_hi, 0x0f0f0f0f
    buffer_load_dwordx4 v[104:107], v15, s[60:63], s11 offen
    s_mov_b32 exec_lo, 0xf0f0f0f0
    s_mov_b32 exec_hi, 0xf0f0f0f0
    buffer_load_dwordx4 v[104:107], v15, s[64:67], s11 offen
    s_add_u32 s11, s11, 28672
    s_mov_b32 exec_lo, 0x0f0f0f0f
    s_mov_b32 exec_hi, 0x0f0f0f0f
    buffer_load_dwordx4 v[108:111], v15, s[60:63], s11 offen
    s_mov_b32 exec_lo, 0xf0f0f0f0
    s_mov_b32 exec_hi, 0xf0f0f0f0
    buffer_load_dwordx4 v[108:111], v15, s[64:67], s11 offen
    s_mov_b64 exec, -1
    s_mul_i32 s11, s8, 28672
    s_lshl_b32 s85, s3, 7
    s_add_u32 s11, s11, s85
    buffer_load_dwordx4 v[112:115], v7, s[68:71], s11 offen offset:0
    buffer_load_dwordx4 v[116:119], v7, s[68:71], s11 offen offset:896
    buffer_load_dwordx4 v[120:123], v7, s[68:71], s11 offen offset:1792
    buffer_load_dwordx4 v[124:127], v7, s[68:71], s11 offen offset:2688
    s_mul_i32 s13, s9, 56
    s_lshl_b32 s14, s3, 3
    s_add_u32 s13, s13, s14
    s_lshl_b32 s13, s13, 11
    s_lshl_b32 s14, s8, 5
    s_add_u32 s13, s13, s14
    s_add_u32 s13, s13, 524288
    v_and_b32 v13, 16, v1
    v_and_b32 v12, 7, v1
    v_lshl_add_u32 v12, v12, 11, v13
    v_add_u32 v12, s13, v12
    v_and_b32 v13, 40, v1
    v_mov_b32 v14, 0x40000000
    v_cmp_eq_u32 vcc, 0, v13
    s_nop 1
    v_cndmask_b32 v77, v14, v12, vcc
    s_cmp_eq_u32 s3, 7
    s_cselect_b32 s14, 0, s10
    s_cmp_eq_u32 s14, 0
    s_cselect_b32 s14, 0x40000000, 0
    v_or_b32 v77, s14, v77
    s_branch L_mlpa
L_reda:
    v_readfirstlane_b32 s13, v49
    s_add_u32 s13, s13, 1
    s_cmp_ge_u32 s13, 112
    s_cbranch_scc1 L_fina
    s_mov_b32 s10, 1
    s_and_b32 s9, s13, 3
    s_lshr_b32 s13, s13, 2
    s_and_b32 s8, s2, 1
    s_mul_i32 s8, s8, 28
    s_add_u32 s8, s8, s13
    s_cmp_lt_u32 s13, 14
    s_cselect_b32 s10, 1, 0
    s_add_u32 s8, s8, s13
    s_mov_b32 s26, 0xcccccccc
    s_mov_b32 s27, 0xcccccccc
    v_and_b32 v12, 1, v1
    v_lshlrev_b32 v12, 2, v12
    v_lshrrev_b32 v13, 5, v1
    v_add_u32 v12, v12, v13
    v_bfe_u32 v13, v1, 4, 1
    v_lshl_add_u32 v12, v13, 1, v12
    v_and_b32 v13, 2, v1
    v_lshl_add_u32 v12, v13, 2, v12
    s_lshl_b32 s13, s8, 3
    v_add_u32 v12, s13, v12
    v_lshlrev_b32 v12, 2, v12
    v_and_b32 v13, 12, v1
    v_mov_b32 v14, 0x40000000
    v_cmp_eq_u32 vcc, 0, v13
    s_nop 1
    v_cndmask_b32 v78, v14, v12, vcc
    s_cmp_eq_u32 s3, 7
    s_cselect_b32 s14, s10, 0
    s_cmp_eq_u32 s14, 0
    s_cselect_b32 s14, 0x40000000, 0
    v_or_b32 v78, s14, v78
    s_lshl_b32 s13, s9, 11
    s_add_u32 s13, s13, 16384
    v_mov_b32 v60, 0
    v_mov_b32 v61, 0
    v_mov_b32 v62, 0
    v_mov_b32 v63, 0
    s_mov_b32 exec_lo, 0x00ff00ff
    s_mov_b32 exec_hi, 0xff00ff00
    ds_write_b128 v8, v[60:63] offset:0
    s_mov_b64 exec, -1
    s_mul_i32 s13, s9, 56
    s_add_u32 s13, s13, s8
    s_lshl_b32 s13, s13, 11
    s_add_u32 s14, s13, 524288
    s_add_u32 s13, s13, 65536
    s_lshl_b32 s15, s9, 14
    s_add_u32 s15, s15, 983040
    v_lshlrev_b32 v10, 4, v1
    v_lshlrev_b32 v11, 5, v1
    v_mov_b32 v12, 0x40000000
    v_cmp_gt_u32 vcc, 56, v1
    s_nop 1
    v_cndmask_b32 v13, v12, v11, vcc
    v_cmp_gt_u32 vcc, 48, v1
    s_nop 1
    v_cndmask_b32 v12, v12, v10, vcc
    s_mul_i32 s85, s9, 896
    v_lshrrev_b32 v11, 1, v10
    v_lshrrev_b32 v14, 1, v12
    v_mov_b32 v79, 0x40000000
    v_cmp_gt_u32 vcc, 54, v1
    s_nop 1
    v_cndmask_b32 v79, v79, v10, vcc
    buffer_load_dwordx2 v[240:241], v11, s[40:43], s85 offen
    buffer_load_dwordx2 v[242:243], v14, s[40:43], s85 offen offset:512
    s_add_u32 s28, s15, 4096
    s_add_u32 s29, s15, 8192
    s_add_u32 s30, s15, 12288
    s_cmp_eq_u32 s10, 0
    s_cbranch_scc1 L_toHa
    s_mov_b32 s16, 0x30d40
L_pollYa:
    buffer_load_dwordx4 v[144:147], v10, s[80:83], s13 offen offset:0 sc1
    buffer_load_dwordx4 v[148:151], v79, s[80:83], s13 offen offset:1024 sc1
    buffer_load_dwordx4 v[152:155], v10, s[80:83], s13 offen offset:2048 sc1
    buffer_load_dwordx4 v[156:159], v79, s[80:83], s13 offen offset:3072 sc1
    s_waitcnt vmcnt(2)
    v_max3_u32 v15, v144, v145, v146
    v_max3_u32 v14, v147, v148, v149
    v_max3_u32 v15, v15, v150, v151
    s_waitcnt vmcnt(0)
    v_max3_u32 v14, v14, v152, v153
    v_max3_u32 v15, v15, v154, v155
    v_max3_u32 v14, v14, v156, v157
    v_max3_u32 v15, v15, v158, v159
    v_max_u32 v15, v15, v14
    v_cmp_eq_u32 vcc, -1, v15
    s_sub_u32 s16, s16, 1
    s_cselect_b64 exec, 0, vcc
    s_cbranch_execnz L_pollYa
    s_mov_b64 exec, -1
    v_add_f32 v60, v144, v148
    v_add_f32 v61, v145, v149
    v_add_f32 v62, v146, v150
    v_add_f32 v63, v147, v151
    v_add_f32 v64, v152, v156
    v_add_f32 v65, v153, v157
    v_add_f32 v66, v154, v158
    v_add_f32 v67, v155, v159
    v_permlane32_swap_b32 v60, v61
    v_permlane32_swap_b32 v62, v63
    v_permlane32_swap_b32 v64, v65
    v_permlane32_swap_b32 v66, v67
    v_add_f32 v60, v60, v61
    v_add_f32 v62, v62, v63
    v_add_f32 v64, v64, v65
    v_add_f32 v66, v66, v67
    v_permlane16_swap_b32 v60, v62
    s_nop 0
    v_permlane16_swap_b32 v64, v66
    v_add_f32 v60, v60, v62
    v_add_f32 v64, v64, v66
    s_nop 0
    v_add_f32_dpp v60, v60, v60 row_ror:8 row_mask:0xf bank_mask:0xf
    v_add_f32_dpp v64, v64, v64 row_ror:8 row_mask:0xf bank_mask:0xf
    s_nop 0
    v_add_f32_dpp v60, v60, v60 row_ror:4 row_mask:0xf bank_mask:0xf
    v_add_f32_dpp v64, v64, v64 row_ror:4 row_mask:0xf bank_mask:0xf
    s_nop 0
    v_add_f32_dpp v60, v60, v60 row_ror:2 row_mask:0xf bank_mask:0xf
    v_add_f32_dpp v64, v64, v64 row_ror:2 row_mask:0xf bank_mask:0xf
    v_cndmask_b32 v60, v60, v64, s[26:27]
    v_min_u32 v51, -2, v60
    buffer_store_dword v51, v78, s[80:83], s15 offen sc1
L_toHa:
    s_mov_b32 s16, 0x30d40
L_pollHa:
    buffer_load_dwordx4 v[176:179], v10, s[80:83], s28 offen offset:0 sc1
    buffer_load_dwordx4 v[180:183], v12, s[80:83], s28 offen offset:1024 sc1
    s_waitcnt vmcnt(0)
    v_lshlrev_b32 v244, 16, v240
    v_and_b32 v245, 0xffff0000, v240
    v_lshlrev_b32 v246, 16, v241
    v_and_b32 v247, 0xffff0000, v241
    v_lshlrev_b32 v248, 16, v242
    v_and_b32 v249, 0xffff0000, v242
    v_lshlrev_b32 v250, 16, v243
    v_and_b32 v251, 0xffff0000, v243
    v_max_u32 v14, v176, v177
    v_max_u32 v15, v178, v179
    v_max3_u32 v14, v14, v180, v181
    v_max3_u32 v15, v15, v182, v183
    v_max_u32 v15, v15, v14
    v_cmp_eq_u32 vcc, -1, v15
    s_sub_u32 s16, s16, 1
    s_cselect_b64 exec, 0, vcc
    s_cbranch_execnz L_pollHa
    s_mov_b64 exec, -1
    s_mov_b64 s[32:33], -1
    s_mov_b64 s[34:35], -1
    s_mov_b64 s[36:37], -1
    s_mov_b64 s[38:39], -1
    s_mov_b64 s[20:21], -1
    s_mov_b32 s16, 0x30d40
L_pollLa:
    s_mov_b64 exec, s[32:33]
    buffer_load_dwordx4 v[168:171], v10, s[80:83], s15 offen offset:2048 sc1
    buffer_load_dwordx4 v[172:175], v12, s[80:83], s15 offen offset:3072 sc1
    s_mov_b64 exec, s[34:35]
    buffer_load_dwordx4 v[184:187], v10, s[80:83], s28 offen offset:2048 sc1
    buffer_load_dwordx4 v[188:191], v12, s[80:83], s28 offen offset:3072 sc1
    s_mov_b64 exec, s[36:37]
    buffer_load_dwordx4 v[192:195], v10, s[80:83], s29 offen offset:0 sc1
    buffer_load_dwordx4 v[196:199], v12, s[80:83], s29 offen offset:1024 sc1
    s_mov_b64 exec, s[38:39]
    buffer_load_dwordx4 v[160:163], v10, s[80:83], s15 offen offset:0 sc1
    buffer_load_dwordx4 v[164:167], v12, s[80:83], s15 offen offset:1024 sc1
    s_mov_b64 exec, s[20:21]
    buffer_load_dwordx4 v[200:203], v10, s[80:83], s29 offen offset:2048 sc1
    buffer_load_dwordx4 v[204:207], v12, s[80:83], s29 offen offset:3072 sc1
    s_mov_b64 exec, -1
    s_waitcnt vmcnt(8)
    v_max3_u32 v14, v168, v169, v170
    v_max3_u32 v13, v171, v172, v173
    v_max3_u32 v14, v14, v174, v175
    v_max_u32 v14, v14, v13
    v_cmp_eq_u32 s[32:33], -1, v14
    s_waitcnt vmcnt(6)
    v_max3_u32 v15, v184, v185, v186
    v_max3_u32 v13, v187, v188, v189
    v_max3_u32 v15, v15, v190, v191
    v_max_u32 v15, v15, v13
    v_cmp_eq_u32 s[34:35], -1, v15
    s_waitcnt vmcnt(4)
    v_max3_u32 v14, v192, v193, v194
    v_max3_u32 v13, v195, v196, v197
    v_max3_u32 v14, v14, v198, v199
    v_max_u32 v14, v14, v13
    v_cmp_eq_u32 s[36:37], -1, v14
    s_waitcnt vmcnt(2)
    v_max3_u32 v15, v160, v161, v162
    v_max3_u32 v13, v163, v164, v165
    v_max3_u32 v15, v15, v166, v167
    v_max_u32 v15, v15, v13
    v_cmp_eq_u32 s[38:39], -1, v15
    s_waitcnt vmcnt(0)
    v_max3_u32 v14, v200, v201, v202
    v_max3_u32 v13, v203, v204, v205
    v_max3_u32 v14, v14, v206, v207
    v_max_u32 v14, v14, v13
    v_cmp_eq_u32 s[20:21], -1, v14
    s_or_b64 vcc, s[32:33], s[34:35]
    s_or_b64 vcc, vcc, s[36:37]
    s_or_b64 vcc, vcc, s[38:39]
    s_or_b64 vcc, vcc, s[20:21]
    s_sub_u32 s16, s16, 1
    s_cselect_b64 exec, 0, vcc
    s_cbranch_execnz L_pollLa
    s_mov_b64 exec, -1
    v_add_f32 v160, v160, v184
    v_add_f32 v161, v161, v185
    v_add_f32 v162, v162, v186
    v_add_f32 v163, v163, v187
    v_add_f32 v164, v164, v188
    v_add_f32 v165, v165, v189
    v_add_f32 v166, v166, v190
    v_add_f32 v167, v167, v191
    v_add_f32 v168, v168, v192
    v_add_f32 v169, v169, v193
    v_add_f32 v170, v170, v194
    v_add_f32 v171, v171, v195
    v_add_f32 v172, v172, v196
    v_add_f32 v173, v173, v197
    v_add_f32 v174, v174, v198
    v_add_f32 v175, v175, v199
    v_add_f32 v176, v176, v200
    v_add_f32 v177, v177, v201
    v_add_f32 v178, v178, v202
    v_add_f32 v179, v179, v203
    v_add_f32 v180, v180, v204
    v_add_f32 v181, v181, v205
    v_add_f32 v182, v182, v206
    v_add_f32 v183, v183, v207
    v_add_f32 v160, v160, v176
    v_add_f32 v161, v161, v177
    v_add_f32 v162, v162, v178
    v_add_f32 v163, v163, v179
    v_add_f32 v164, v164, v180
    v_add_f32 v165, v165, v181
    v_add_f32 v166, v166, v182
    v_add_f32 v167, v167, v183
    v_add_f32 v160, v160, v168
    v_add_f32 v161, v161, v169
    v_add_f32 v162, v162, v170
    v_add_f32 v163, v163, v171
    v_add_f32 v164, v164, v172
    v_add_f32 v165, v165, v173
    v_add_f32 v166, v166, v174
    v_add_f32 v167, v167, v175
    v_cvt_pk_bf16_f32 v160, v160, v161
    v_cvt_pk_bf16_f32 v161, v162, v163
    v_cvt_pk_bf16_f32 v162, v164, v165
    v_cvt_pk_bf16_f32 v163, v166, v167
    v_lshlrev_b32 v60, 16, v160
    v_and_b32 v61, 0xffff0000, v160
    v_lshlrev_b32 v62, 16, v161
    v_and_b32 v63, 0xffff0000, v161
    v_lshlrev_b32 v64, 16, v162
    v_and_b32 v65, 0xffff0000, v162
    v_lshlrev_b32 v66, 16, v163
    v_and_b32 v67, 0xffff0000, v163
    v_add_f32 v60, v60, v244
    v_add_f32 v61, v61, v245
    v_add_f32 v62, v62, v246
    v_add_f32 v63, v63, v247
    v_add_f32 v64, v64, v248
    v_add_f32 v65, v65, v249
    v_add_f32 v66, v66, v250
    v_add_f32 v67, v67, v251
    v_cvt_pk_bf16_f32 v160, v60, v61
    v_cvt_pk_bf16_f32 v161, v62, v63
    v_cvt_pk_bf16_f32 v162, v64, v65
    v_cvt_pk_bf16_f32 v163, v66, v67
    v_lshlrev_b32 v60, 16, v160
    v_and_b32 v61, 0xffff0000, v160
    v_lshlrev_b32 v62, 16, v161
    v_and_b32 v63, 0xffff0000, v161
    v_lshlrev_b32 v64, 16, v162
    v_and_b32 v65, 0xffff0000, v162
    v_lshlrev_b32 v66, 16, v163
    v_and_b32 v67, 0xffff0000, v163
    v_add_f32 v52, v60, v61
    v_mul_f32 v53, v60, v60
    v_fmac_f32 v53, v61, v61
    v_add_f32 v52, v52, v62
    v_fmac_f32 v53, v62, v62
    v_add_f32 v52, v52, v63
    v_fmac_f32 v53, v63, v63
    v_add_f32 v52, v52, v64
    v_fmac_f32 v53, v64, v64
    v_add_f32 v52, v52, v65
    v_fmac_f32 v53, v65, v65
    v_add_f32 v52, v52, v66
    v_fmac_f32 v53, v66, v66
    v_add_f32 v52, v52, v67
    v_fmac_f32 v53, v67, v67
    s_nop 0
    v_add_f32_dpp v52, v52, v52 quad_perm:[1,0,3,2] row_mask:0xf bank_mask:0xf
    v_add_f32_dpp v53, v53, v53 quad_perm:[1,0,3,2] row_mask:0xf bank_mask:0xf
    s_nop 0
    v_add_f32_dpp v52, v52, v52 quad_perm:[2,3,0,1] row_mask:0xf bank_mask:0xf
    v_add_f32_dpp v53, v53, v53 quad_perm:[2,3,0,1] row_mask:0xf bank_mask:0xf
    s_nop 0
    v_add_f32_dpp v52, v52, v52 row_half_mirror row_mask:0xf bank_mask:0xf
    v_add_f32_dpp v53, v53, v53 row_half_mirror row_mask:0xf bank_mask:0xf
    s_nop 0
    v_add_f32_dpp v52, v52, v52 row_mirror row_mask:0xf bank_mask:0xf
    v_add_f32_dpp v53, v53, v53 row_mirror row_mask:0xf bank_mask:0xf
    v_mov_b32 v54, v52
    v_mov_b32 v55, v53
    s_nop 0
    v_permlane16_swap_b32 v52, v54
    v_permlane16_swap_b32 v53, v55
    v_add_f32 v52, v52, v54
    v_add_f32 v53, v53, v55
    v_mov_b32 v54, v52
    v_mov_b32 v55, v53
    s_nop 0
    v_permlane32_swap_b32 v52, v54
    v_permlane32_swap_b32 v53, v55
    v_add_f32 v52, v52, v54
    v_add_f32 v53, v53, v55
    v_mul_f32 v52, 0x3b124925, v52
    v_mul_f32 v53, 0x3b124925, v53
    v_fma_f32 v53, -v52, v52, v53
    v_max_f32 v53, 0, v53
    v_cvt_pk_bf16_f32 v52, v52, v53
    v_and_b32 v53, 0xffff0000, v52
    v_lshlrev_b32 v52, 16, v52
    v_add_f32 v53, 0x3727c5ac, v53
    v_cvt_pk_bf16_f32 v53, v53, v53
    v_and_b32 v53, 0xffff0000, v53
    v_sqrt_f32 v53, v53
    s_nop 0
    v_cvt_pk_bf16_f32 v53, v53, v53
    v_and_b32 v53, 0xffff0000, v53
    v_rcp_f32 v53, v53
    v_sub_f32 v60, v60, v52
    v_sub_f32 v61, v61, v52
    v_sub_f32 v62, v62, v52
    v_sub_f32 v63, v63, v52
    v_sub_f32 v64, v64, v52
    v_sub_f32 v65, v65, v52
    v_sub_f32 v66, v66, v52
    v_sub_f32 v67, v67, v52
    v_cvt_pk_bf16_f32 v60, v60, v60
    v_cvt_pk_bf16_f32 v61, v61, v61
    v_cvt_pk_bf16_f32 v62, v62, v62
    v_cvt_pk_bf16_f32 v63, v63, v63
    v_cvt_pk_bf16_f32 v64, v64, v64
    v_cvt_pk_bf16_f32 v65, v65, v65
    v_cvt_pk_bf16_f32 v66, v66, v66
    v_cvt_pk_bf16_f32 v67, v67, v67
    v_and_b32 v60, 0xffff0000, v60
    v_and_b32 v61, 0xffff0000, v61
    v_and_b32 v62, 0xffff0000, v62
    v_and_b32 v63, 0xffff0000, v63
    v_and_b32 v64, 0xffff0000, v64
    v_and_b32 v65, 0xffff0000, v65
    v_and_b32 v66, 0xffff0000, v66
    v_and_b32 v67, 0xffff0000, v67
    v_mul_f32 v60, v60, v53
    v_mul_f32 v61, v61, v53
    v_mul_f32 v62, v62, v53
    v_mul_f32 v63, v63, v53
    v_mul_f32 v64, v64, v53
    v_mul_f32 v65, v65, v53
    v_mul_f32 v66, v66, v53
    v_mul_f32 v67, v67, v53
    v_cvt_pk_bf16_f32 v60, v60, v60
    v_cvt_pk_bf16_f32 v61, v61, v61
    v_cvt_pk_bf16_f32 v62, v62, v62
    v_cvt_pk_bf16_f32 v63, v63, v63
    v_cvt_pk_bf16_f32 v64, v64, v64
    v_cvt_pk_bf16_f32 v65, v65, v65
    v_cvt_pk_bf16_f32 v66, v66, v66
    v_cvt_pk_bf16_f32 v67, v67, v67
    ds_write_b128 v10, v[60:63] offset:58880
    ds_write_b128 v10, v[64:67] offset:59904
    s_waitcnt lgkmcnt(0)
    s_barrier
    s_barrier
    s_branch L_outa
L_mlpa:
    v_lshrrev_b32 v14, 3, v1
    s_mul_i32 s85, s3, 256
    v_lshlrev_b32 v14, 2, v14
    v_add_u32 v14, s85, v14
    s_lshl_b32 s85, s3, 7
    v_subrev_u32 v15, s85, v9
    s_barrier
    ds_read_b32 v32, v14 offset:58880
    ds_read_b32 v33, v14 offset:58912
    ds_read_b32 v34, v14 offset:58944
    ds_read_b32 v35, v14 offset:58976
    ds_read_b32 v36, v14 offset:59008
    ds_read_b32 v37, v14 offset:59040
    ds_read_b32 v38, v14 offset:59072
    ds_read_b32 v39, v14 offset:59104
    s_waitcnt vmcnt(0)
    s_waitcnt lgkmcnt(7)
    v_and_b32 v52, v32, v3
    v_and_b32 v53, v32, v4
    v_and_b32 v54, v32, v5
    v_and_b32 v55, v32, v6
    s_nop 1
    v_mfma_f32_16x16x32_bf16 v[68:71], v[52:55], v[80:83], 0
    s_waitcnt lgkmcnt(6)
    v_and_b32 v56, v33, v3
    v_and_b32 v57, v33, v4
    v_and_b32 v58, v33, v5
    v_and_b32 v59, v33, v6
    s_nop 1
    v_mfma_f32_16x16x32_bf16 v[68:71], v[56:59], v[84:87], v[68:71]
    s_waitcnt lgkmcnt(5)
    v_and_b32 v52, v34, v3
    v_and_b32 v53, v34, v4
    v_and_b32 v54, v34, v5
    v_and_b32 v55, v34, v6
    s_nop 1
    v_mfma_f32_16x16x32_bf16 v[68:71], v[52:55], v[88:91], v[68:71]
    s_waitcnt lgkmcnt(4)
    v_and_b32 v56, v35, v3
    v_and_b32 v57, v35, v4
    v_and_b32 v58, v35, v5
    v_and_b32 v59, v35, v6
    s_nop 1
    v_mfma_f32_16x16x32_bf16 v[68:71], v[56:59], v[92:95], v[68:71]
    s_waitcnt lgkmcnt(3)
    v_and_b32 v52, v36, v3
    v_and_b32 v53, v36, v4
    v_and_b32 v54, v36, v5
    v_and_b32 v55, v36, v6
    s_nop 1
    v_mfma_f32_16x16x32_bf16 v[68:71], v[52:55], v[96:99], v[68:71]
    s_waitcnt lgkmcnt(2)
    v_and_b32 v56, v37, v3
    v_and_b32 v57, v37, v4
    v_and_b32 v58, v37, v5
    v_and_b32 v59, v37, v6
    s_nop 1
    v_mfma_f32_16x16x32_bf16 v[68:71], v[56:59], v[100:103], v[68:71]
    s_waitcnt lgkmcnt(1)
    v_and_b32 v52, v38, v3
    v_and_b32 v53, v38, v4
    v_and_b32 v54, v38, v5
    v_and_b32 v55, v38, v6
    s_nop 1
    v_mfma_f32_16x16x32_bf16 v[68:71], v[52:55], v[104:107], v[68:71]
    s_waitcnt lgkmcnt(0)
    v_and_b32 v56, v39, v3
    v_and_b32 v57, v39, v4
    v_and_b32 v58, v39, v5
    v_and_b32 v59, v39, v6
    s_nop 1
    v_mfma_f32_16x16x32_bf16 v[68:71], v[56:59], v[108:111], v[68:71]
    s_mov_b32 exec_lo, 0x00ff00ff
    s_mov_b32 exec_hi, 0xff00ff00
    s_nop 5
    ds_write_b128 v8, v[68:71] offset:0
    s_mov_b64 exec, -1
    s_waitcnt lgkmcnt(0)
    s_barrier
    s_cmp_eq_u32 s3, 7
    s_cbranch_scc1 L_outa
    ds_read_b128 v[16:19], v15 offset:0
    ds_read_b128 v[20:23], v15 offset:14592
    ds_read_b128 v[24:27], v15 offset:128
    ds_read_b128 v[28:31], v15 offset:14720
    s_waitcnt lgkmcnt(2)
    v_add_f32 v16, v16, v20
    v_add_f32 v17, v17, v21
    v_add_f32 v18, v18, v22
    v_add_f32 v19, v19, v23
    s_waitcnt lgkmcnt(0)
    v_add_f32 v20, v24, v28
    v_add_f32 v21, v25, v29
    v_add_f32 v22, v26, v30
    v_add_f32 v23, v27, v31
    v_add_f32_dpp v16, v16, v16 quad_perm:[1,0,3,2] row_mask:0xf bank_mask:0xf
    v_add_f32_dpp v17, v17, v17 quad_perm:[1,0,3,2] row_mask:0xf bank_mask:0xf
    v_add_f32_dpp v18, v18, v18 quad_perm:[1,0,3,2] row_mask:0xf bank_mask:0xf
    v_add_f32_dpp v19, v19, v19 quad_perm:[1,0,3,2] row_mask:0xf bank_mask:0xf
    v_add_f32_dpp v20, v20, v20 quad_perm:[1,0,3,2] row_mask:0xf bank_mask:0xf
    v_add_f32_dpp v21, v21, v21 quad_perm:[1,0,3,2] row_mask:0xf bank_mask:0xf
    v_add_f32_dpp v22, v22, v22 quad_perm:[1,0,3,2] row_mask:0xf bank_mask:0xf
    v_add_f32_dpp v23, v23, v23 quad_perm:[1,0,3,2] row_mask:0xf bank_mask:0xf
    v_add_f32_dpp v16, v16, v16 quad_perm:[2,3,0,1] row_mask:0xf bank_mask:0xf
    v_add_f32_dpp v17, v17, v17 quad_perm:[2,3,0,1] row_mask:0xf bank_mask:0xf
    v_add_f32_dpp v18, v18, v18 quad_perm:[2,3,0,1] row_mask:0xf bank_mask:0xf
    v_add_f32_dpp v19, v19, v19 quad_perm:[2,3,0,1] row_mask:0xf bank_mask:0xf
    v_add_f32_dpp v20, v20, v20 quad_perm:[2,3,0,1] row_mask:0xf bank_mask:0xf
    v_add_f32_dpp v21, v21, v21 quad_perm:[2,3,0,1] row_mask:0xf bank_mask:0xf
    v_add_f32_dpp v22, v22, v22 quad_perm:[2,3,0,1] row_mask:0xf bank_mask:0xf
    v_add_f32_dpp v23, v23, v23 quad_perm:[2,3,0,1] row_mask:0xf bank_mask:0xf
    v_add_f32_dpp v16, v16, v16 row_half_mirror row_mask:0xf bank_mask:0xf
    v_add_f32_dpp v17, v17, v17 row_half_mirror row_mask:0xf bank_mask:0xf
    v_add_f32_dpp v18, v18, v18 row_half_mirror row_mask:0xf bank_mask:0xf
    v_add_f32_dpp v19, v19, v19 row_half_mirror row_mask:0xf bank_mask:0xf
    v_add_f32_dpp v20, v20, v20 row_half_mirror row_mask:0xf bank_mask:0xf
    v_add_f32_dpp v21, v21, v21 row_half_mirror row_mask:0xf bank_mask:0xf
    v_add_f32_dpp v22, v22, v22 row_half_mirror row_mask:0xf bank_mask:0xf
    v_add_f32_dpp v23, v23, v23 row_half_mirror row_mask:0xf bank_mask:0xf
    v_cvt_pk_bf16_f32 v16, v16, v20
    v_cvt_pk_bf16_f32 v17, v17, v21
    v_cvt_pk_bf16_f32 v18, v18, v22
    v_cvt_pk_bf16_f32 v19, v19, v23
    v_lshlrev_b32 v20, 16, v16
    v_lshlrev_b32 v21, 16, v17
    v_lshlrev_b32 v22, 16, v18
    v_lshlrev_b32 v23, 16, v19
    v_mul_f32 v24, 0xbfb8aa3b, v20
    v_mul_f32 v25, 0xbfb8aa3b, v21
    v_mul_f32 v26, 0xbfb8aa3b, v22
    v_mul_f32 v27, 0xbfb8aa3b, v23
    v_exp_f32 v24, v24
    v_exp_f32 v25, v25
    v_exp_f32 v26, v26
    v_exp_f32 v27, v27
    v_add_f32 v24, 1.0, v24
    v_add_f32 v25, 1.0, v25
    v_add_f32 v26, 1.0, v26
    v_add_f32 v27, 1.0, v27
    v_rcp_f32 v24, v24
    v_rcp_f32 v25, v25
    v_rcp_f32 v26, v26
    v_rcp_f32 v27, v27
    v_and_b32 v16, 0xffff0000, v16
    v_and_b32 v17, 0xffff0000, v17
    v_and_b32 v18, 0xffff0000, v18
    v_and_b32 v19, 0xffff0000, v19
    v_mul_f32 v20, v20, v24
    v_mul_f32 v21, v21, v25
    v_mul_f32 v22, v22, v26
    v_mul_f32 v23, v23, v27
    v_cvt_pk_bf16_f32 v20, v20, v20
    v_cvt_pk_bf16_f32 v21, v21, v21
    v_cvt_pk_bf16_f32 v22, v22, v22
    v_cvt_pk_bf16_f32 v23, v23, v23
    v_and_b32 v20, 0xffff0000, v20
    v_and_b32 v21, 0xffff0000, v21
    v_and_b32 v22, 0xffff0000, v22
    v_and_b32 v23, 0xffff0000, v23
    v_mul_f32 v16, v16, v20
    v_mul_f32 v17, v17, v21
    v_mul_f32 v18, v18, v22
    v_mul_f32 v19, v19, v23
    v_cvt_pk_bf16_f32 v16, v16, v16
    v_cvt_pk_bf16_f32 v17, v17, v17
    v_cvt_pk_bf16_f32 v18, v18, v18
    v_cvt_pk_bf16_f32 v19, v19, v19
    v_and_b32 v52, v16, v3
    v_and_b32 v53, v16, v4
    v_and_b32 v54, v16, v5
    v_and_b32 v55, v16, v6
    s_nop 1
    v_mfma_f32_16x16x32_bf16 v[60:63], v[52:55], v[112:115], 0
    v_and_b32 v56, v17, v3
    v_and_b32 v57, v17, v4
    v_and_b32 v58, v17, v5
    v_and_b32 v59, v17, v6
    s_nop 1
    v_mfma_f32_16x16x32_bf16 v[60:63], v[56:59], v[116:119], v[60:63]
    v_and_b32 v52, v18, v3
    v_and_b32 v53, v18, v4
    v_and_b32 v54, v18, v5
    v_and_b32 v55, v18, v6
    s_nop 1
    v_mfma_f32_16x16x32_bf16 v[60:63], v[52:55], v[120:123], v[60:63]
    v_and_b32 v56, v19, v3
    v_and_b32 v57, v19, v4
    v_and_b32 v58, v19, v5
    v_and_b32 v59, v19, v6
    s_nop 1
    v_mfma_f32_16x16x32_bf16 v[60:63], v[56:59], v[124:127], v[60:63]
    s_nop 7
    v_mov_b32 v64, v60
    v_mov_b32 v65, v61
    v_mov_b32 v66, v62
    v_mov_b32 v67, v63
    v_permlane32_swap_b32 v60, v64
    v_permlane32_swap_b32 v61, v65
    v_permlane32_swap_b32 v62, v66
    v_permlane32_swap_b32 v63, v67
    v_add_f32_dpp v60, v64, v60 row_ror:8 row_mask:0xf bank_mask:0xf
    v_add_f32_dpp v61, v65, v61 row_ror:8 row_mask:0xf bank_mask:0xf
    v_add_f32_dpp v62, v66, v62 row_ror:8 row_mask:0xf bank_mask:0xf
    v_add_f32_dpp v63, v67, v63 row_ror:8 row_mask:0xf bank_mask:0xf
    v_min_u32 v60, -2, v60
    v_min_u32 v61, -2, v61
    v_min_u32 v62, -2, v62
    v_min_u32 v63, -2, v63
    buffer_store_dwordx4 v[60:63], v77, s[80:83], 0 offen sc1
    s_branch L_fina
L_outa:
    s_cmp_eq_u32 s10, 0
    s_cbranch_scc1 L_fina
    ds_write_b64 v11, v[160:161] offset:29184
    ds_write_b64 v11, v[162:163] offset:29696
    v_bfe_u32 v14, v78, 1, 10
    s_waitcnt lgkmcnt(0)
    ds_read_u16 v51, v14 offset:29184
    s_waitcnt lgkmcnt(0)
    v_lshlrev_b32 v51, 16, v51
    s_mov_b32 s16, 0x30d40
L_pollZa:
    buffer_load_dwordx4 v[144:147], v10, s[80:83], s14 offen offset:0 sc1
    buffer_load_dwordx4 v[148:151], v12, s[80:83], s14 offen offset:1024 sc1
    buffer_load_dwordx4 v[152:155], v10, s[80:83], s14 offen offset:2048 sc1
    buffer_load_dwordx4 v[156:159], v12, s[80:83], s14 offen offset:3072 sc1
    s_waitcnt vmcnt(2)
    v_max3_u32 v15, v144, v145, v146
    v_max3_u32 v14, v147, v148, v149
    v_max3_u32 v15, v15, v150, v151
    s_waitcnt vmcnt(0)
    v_max3_u32 v14, v14, v152, v153
    v_max3_u32 v15, v15, v154, v155
    v_max3_u32 v14, v14, v156, v157
    v_max3_u32 v15, v15, v158, v159
    v_max_u32 v15, v15, v14
    v_cmp_eq_u32 vcc, -1, v15
    s_sub_u32 s16, s16, 1
    s_cselect_b64 exec, 0, vcc
    s_cbranch_execnz L_pollZa
    s_mov_b64 exec, -1
    v_add_f32 v60, v144, v148
    v_add_f32 v61, v145, v149
    v_add_f32 v62, v146, v150
    v_add_f32 v63, v147, v151
    v_add_f32 v64, v152, v156
    v_add_f32 v65, v153, v157
    v_add_f32 v66, v154, v158
    v_add_f32 v67, v155, v159
    v_permlane32_swap_b32 v60, v61
    v_permlane32_swap_b32 v62, v63
    v_permlane32_swap_b32 v64, v65
    v_permlane32_swap_b32 v66, v67
    v_add_f32 v60, v60, v61
    v_add_f32 v62, v62, v63
    v_add_f32 v64, v64, v65
    v_add_f32 v66, v66, v67
    v_permlane16_swap_b32 v60, v62
    s_nop 0
    v_permlane16_swap_b32 v64, v66
    v_add_f32 v60, v60, v62
    v_add_f32 v64, v64, v66
    s_nop 0
    v_add_f32_dpp v60, v60, v60 row_ror:8 row_mask:0xf bank_mask:0xf
    v_add_f32_dpp v64, v64, v64 row_ror:8 row_mask:0xf bank_mask:0xf
    s_nop 0
    v_add_f32_dpp v60, v60, v60 row_ror:4 row_mask:0xf bank_mask:0xf
    v_add_f32_dpp v64, v64, v64 row_ror:4 row_mask:0xf bank_mask:0xf
    s_nop 0
    v_add_f32_dpp v60, v60, v60 row_ror:2 row_mask:0xf bank_mask:0xf
    v_add_f32_dpp v64, v64, v64 row_ror:2 row_mask:0xf bank_mask:0xf
    v_cndmask_b32 v60, v60, v64, s[26:27]
    v_cvt_pk_bf16_f32 v60, v60, v60
    v_and_b32 v60, 0xffff0000, v60
    v_add_f32 v51, v51, v60
    v_cvt_pk_bf16_f32 v51, v51, v51
    s_mul_i32 s15, s9, 896
    v_lshrrev_b32 v14, 1, v78
    buffer_store_short v51, v14, s[72:75], s15 offen
    s_waitcnt vmcnt(0)
L_fina:
    s_endpgm
L_end:
    s_endpgm
.section .rodata,"a"
.p2align 6
.amdhsa_kernel sequential_preLN__mha_block_cached__glu_gated_swiglu__decode_kernel
  .amdhsa_next_free_vgpr 256
  .amdhsa_next_free_sgpr 102
  .amdhsa_accum_offset 256
  .amdhsa_group_segment_fixed_size 0
  .amdhsa_kernarg_size 96
  .amdhsa_user_sgpr_count 2
  .amdhsa_user_sgpr_kernarg_segment_ptr 1
  .amdhsa_system_sgpr_workgroup_id_x 1
.end_amdhsa_kernel
```
